```python
import torch

def _softmax(x, axis=-1):
    return torch.softmax(x, dim=axis)
def _gelu(x):
    return torch.nn.functional.gelu(x, approximate="tanh")
def _silu(x):
    return torch.nn.functional.silu(x)
def _sigmoid(x):
    return torch.sigmoid(x)
def _layernorm(x, axis=-1, eps=1e-5):
    m = x.mean(dim=axis, keepdim=True)
    v = x.var(dim=axis, keepdim=True, unbiased=False)
    return (x - m) / torch.sqrt(v + eps)
def _scatter_add(tgt, idx, src, axis=0):
    return tgt.clone().index_add_(axis, idx, src)
def _segment_sum(src, seg, n):
    out = torch.zeros((n,) + src.shape[1:], dtype=src.dtype)
    return out.index_add_(0, seg, src)
def _pad(x, pw):
    flat = tuple(v for pair in reversed(pw) for v in pair)
    return torch.nn.functional.pad(x, flat)

kernel_name = 'standalone__molecular_angular_gemnet__graph'

def setup_inputs():

    _w = (lambda a: (lambda t: t.to(torch.bfloat16) if t.is_floating_point() else t)(torch.as_tensor(a)))
    N, deg, De, L = 10000, 32, 4, 3
    E = N * deg
    T = E * deg
    NR = 8
    dist = torch.rand(E).to(float)
    angle = (torch.rand(T) * torch.pi).to(float)
    centers = torch.linspace(0.0, 1.0, NR).to(float)
    ang_freq = torch.arange(1, L + 1).to(float)
    return {
        "m": _w((lambda *s: torch.randn(*s, dtype=torch.bfloat16) * 0.05)(E, De)),
        "idx_in": _w((lambda lo, hi, *s: torch.randint(lo, hi, s))(0, E, T).to(torch.int64)),
        "idx_out": _w((lambda lo, hi, *s: torch.randint(lo, hi, s))(0, E, T).to(torch.int64)),
        "dist": _w(dist),
        "angle": _w(angle),
        "centers": _w(centers),
        "ang_freq": _w(ang_freq),
        "w_rbf": _w((lambda *s: torch.randn(*s, dtype=torch.bfloat16) * 0.2)(NR, De)),
        "w_sbf": _w((lambda *s: torch.randn(*s, dtype=torch.bfloat16) * 0.2)(NR * L, De)),
        "w_down": _w((lambda *s: torch.randn(*s, dtype=torch.bfloat16) * 0.2)(De, De)),
        "w_up": _w((lambda *s: torch.randn(*s, dtype=torch.bfloat16) * 0.2)(De, De)),
    }

def reference(m, idx_in, idx_out, dist, angle, centers, ang_freq, w_rbf, w_sbf, w_down, w_up):
    E, De = m.shape[0], m.shape[1]
    NR = centers.shape[0]
    L = ang_freq.shape[0]
    rbf = torch.exp(-10.0 * (dist[:, None] - centers[None, :]) ** 2)
    cbf = torch.cos(ang_freq[None, :] * angle[:, None])
    rbf_t = rbf[idx_out]
    sbf = torch.reshape(rbf_t[:, :, None] * cbf[:, None, :], (-1, NR * L))
    x = (m[idx_in] @ w_down) * (sbf @ w_sbf)
    agg = _segment_sum(x, idx_out, E)
    return m + (agg @ w_up) * (rbf @ w_rbf)
```

```asm
; @launch kernel=part_kernel grid=(251,1,1) block=(1024,1,1) lds=128512
; @launch kernel=accum_kernel grid=(256,1,1) block=(1024,1,1) lds=163328
.amdgcn_target "amdgcn-amd-amdhsa--gfx950"
.text
.globl part_kernel
.p2align 8
.type part_kernel,@function
part_kernel:
    s_cmp_ge_u32 s2, 250
    s_cbranch_scc1 part_aux
    s_load_dwordx4 s[4:7], s[0:1], 8
    s_load_dwordx2 s[38:39], s[0:1], 32
    s_load_dwordx2 s[28:29], s[0:1], 104
    s_load_dwordx2 s[64:65], s[0:1], 0
    s_load_dwordx2 s[66:67], s[0:1], 24
    s_setprio 3
    v_lshlrev_b32 v1, 4, v0
    v_lshlrev_b32 v2, 3, v0
    v_mov_b32 v3, 1
    v_mov_b32 v4, 21846
    v_mov_b32 v8, 0
    v_mov_b32 v9, 0
    v_lshrrev_b32 v10, 6, v0
    s_mul_i32 s30, s2, 16384
    s_mul_i32 s31, s2, 8192
    v_readfirstlane_b32 s37, v10
    ds_write_b64 v2, v[8:9]
    s_mov_b32 s33, -1250
    s_mov_b32 s34, -834
    s_mov_b32 s72, -384
    s_mov_b32 s35, 0x38803880
    s_mov_b32 s36, 0x57ff57ff
    s_add_u32 s32, s2, 0
    s_lshr_b32 s32, s32, 2
    s_and_b32 s32, s32, 60
    s_sub_u32 s73, 64, s32
    s_mul_i32 s75, s32, 0x100401
    s_add_u32 s32, s2, 250
    s_lshr_b32 s32, s32, 2
    s_and_b32 s32, s32, 60
    s_sub_u32 s74, 64, s32
    s_mul_i32 s76, s32, 0x100401
    v_lshlrev_b32 v5, 2, v0
    v_mul_u32_u24 v6, 12, v0
    s_mov_b32 s77, 786432
    s_mov_b32 s78, 0
    s_waitcnt lgkmcnt(0)
    s_mov_b32 s8, s4
    s_mov_b32 s9, s5
    s_mov_b32 s10, 0x2710000
    s_mov_b32 s11, 0x20000
    s_mov_b32 s12, s6
    s_mov_b32 s13, s7
    s_mov_b32 s14, 0x2710000
    s_mov_b32 s15, 0x20000
    s_mov_b32 s16, s38
    s_mov_b32 s17, s39
    s_mov_b32 s18, 0x1388000
    s_mov_b32 s19, 0x20000
    s_add_u32 s32, s30, 0
    buffer_load_dwordx4 v[16:19], v1, s[12:15], s32 offen nt
    buffer_load_dwordx4 v[20:23], v1, s[8:11], s32 offen nt
    s_add_u32 s32, s31, 0
    buffer_load_dwordx2 v[24:25], v2, s[16:19], s32 offen nt
    s_barrier
    s_add_u32 s32, s30, 4096000
    buffer_load_dwordx4 v[26:29], v1, s[12:15], s32 offen nt
    buffer_load_dwordx4 v[30:33], v1, s[8:11], s32 offen nt
    s_add_u32 s32, s31, 2048000
    buffer_load_dwordx2 v[34:35], v2, s[16:19], s32 offen nt
    s_add_u32 s32, s30, 8192000
    buffer_load_dwordx4 v[36:39], v1, s[12:15], s32 offen nt
    buffer_load_dwordx4 v[40:43], v1, s[8:11], s32 offen nt
    s_add_u32 s32, s31, 4096000
    buffer_load_dwordx2 v[44:45], v2, s[16:19], s32 offen nt
    s_add_u32 s32, s30, 12288000
    buffer_load_dwordx4 v[46:49], v1, s[12:15], s32 offen nt
    buffer_load_dwordx4 v[50:53], v1, s[8:11], s32 offen nt
    s_add_u32 s32, s31, 6144000
    buffer_load_dwordx2 v[54:55], v2, s[16:19], s32 offen nt
    s_add_u32 s32, s30, 16384000
    buffer_load_dwordx4 v[56:59], v1, s[12:15], s32 offen nt
    buffer_load_dwordx4 v[60:63], v1, s[8:11], s32 offen nt
    s_add_u32 s32, s31, 8192000
    buffer_load_dwordx2 v[64:65], v2, s[16:19], s32 offen nt
    s_setprio 0
    v_mov_b32 v8, s75
    ds_write_b32 v5, v8 offset:8320
    ds_write_b32 v5, v8 offset:12416
    ds_write_b32 v5, v8 offset:16512
    ds_write_b32 v5, v8 offset:20608
    ds_write_b32 v5, v8 offset:24704
    ds_write_b32 v5, v8 offset:28800
    ds_write_b32 v5, v8 offset:32896
    v_cmp_gt_u32 vcc, 344, v0
    s_mov_b64 exec, vcc
    ds_write_b32 v5, v8 offset:36992
    s_mov_b64 exec, -1
    s_waitcnt vmcnt(12)
    v_and_b32 v24, 0x7fff7fff, v24
    v_pk_max_u16 v24, v24, s35
    v_pk_min_u16 v24, v24, s36
    v_subrev_u32 v24, 0x38003800, v24
    v_and_b32 v25, 0x7fff7fff, v25
    v_pk_max_u16 v25, v25, s35
    v_pk_min_u16 v25, v25, s36
    v_subrev_u32 v25, 0x38003800, v25
    v_mul_hi_u32_u24 v120, 3435974, v16
    v_mul_hi_u32_u24 v121, 5149841, v20
    v_mad_i32_i24 v16, v120, s33, v16
    v_mad_i32_i24 v20, v121, s34, v20
    v_and_b32 v122, 3, v16
    v_and_b32 v16, -4, v16
    v_lshl_add_u32 v121, v121, 2, v122
    v_lshl_add_u32 v20, v16, 8, v20
    v_mul_hi_u32_u24 v122, 11184811, v121
    v_lshl_or_b32 v20, v24, 19, v20
    v_mad_i32_i24 v121, v122, s72, v121
    v_lshl_or_b32 v120, v120, 2, v122
    v_lshl_add_u32 v121, v121, 2, s73
    v_lshl_or_b32 v16, v120, 18, v121
    v_lshrrev_b32 v123, 16, v16
    ds_add_u32 v123, v3 offset:0
    v_mul_hi_u32_u24 v120, 3435974, v17
    v_mul_hi_u32_u24 v121, 5149841, v21
    v_mad_i32_i24 v17, v120, s33, v17
    v_mad_i32_i24 v21, v121, s34, v21
    v_and_b32 v122, 3, v17
    v_and_b32 v17, -4, v17
    v_lshl_add_u32 v121, v121, 2, v122
    v_lshl_add_u32 v21, v17, 8, v21
    v_mul_hi_u32_u24 v122, 11184811, v121
    v_and_b32 v17, 0x1fff0000, v24
    v_lshl_or_b32 v21, v17, 3, v21
    v_mad_i32_i24 v121, v122, s72, v121
    v_lshl_or_b32 v120, v120, 2, v122
    v_lshl_add_u32 v121, v121, 2, s73
    v_lshl_or_b32 v17, v120, 18, v121
    v_lshrrev_b32 v124, 16, v17
    ds_add_u32 v124, v3 offset:0
    v_mul_hi_u32_u24 v120, 3435974, v18
    v_mul_hi_u32_u24 v121, 5149841, v22
    v_mad_i32_i24 v18, v120, s33, v18
    v_mad_i32_i24 v22, v121, s34, v22
    v_and_b32 v122, 3, v18
    v_and_b32 v18, -4, v18
    v_lshl_add_u32 v121, v121, 2, v122
    v_lshl_add_u32 v22, v18, 8, v22
    v_mul_hi_u32_u24 v122, 11184811, v121
    v_lshl_or_b32 v22, v25, 19, v22
    v_mad_i32_i24 v121, v122, s72, v121
    v_lshl_or_b32 v120, v120, 2, v122
    v_lshl_add_u32 v121, v121, 2, s73
    v_lshl_or_b32 v18, v120, 18, v121
    v_lshrrev_b32 v125, 16, v18
    ds_add_u32 v125, v3 offset:0
    v_mul_hi_u32_u24 v120, 3435974, v19
    v_mul_hi_u32_u24 v121, 5149841, v23
    v_mad_i32_i24 v19, v120, s33, v19
    v_mad_i32_i24 v23, v121, s34, v23
    v_and_b32 v122, 3, v19
    v_and_b32 v19, -4, v19
    v_lshl_add_u32 v121, v121, 2, v122
    v_lshl_add_u32 v23, v19, 8, v23
    v_mul_hi_u32_u24 v122, 11184811, v121
    v_and_b32 v19, 0x1fff0000, v25
    v_lshl_or_b32 v23, v19, 3, v23
    v_mad_i32_i24 v121, v122, s72, v121
    v_lshl_or_b32 v120, v120, 2, v122
    v_lshl_add_u32 v121, v121, 2, s73
    v_lshl_or_b32 v19, v120, 18, v121
    v_lshrrev_b32 v126, 16, v19
    ds_add_u32 v126, v3 offset:0
    s_waitcnt vmcnt(9)
    v_and_b32 v34, 0x7fff7fff, v34
    v_pk_max_u16 v34, v34, s35
    v_pk_min_u16 v34, v34, s36
    v_subrev_u32 v34, 0x38003800, v34
    v_and_b32 v35, 0x7fff7fff, v35
    v_pk_max_u16 v35, v35, s35
    v_pk_min_u16 v35, v35, s36
    v_subrev_u32 v35, 0x38003800, v35
    v_mul_hi_u32_u24 v120, 3435974, v26
    v_mul_hi_u32_u24 v121, 5149841, v30
    v_mad_i32_i24 v26, v120, s33, v26
    v_mad_i32_i24 v30, v121, s34, v30
    v_and_b32 v122, 3, v26
    v_and_b32 v26, -4, v26
    v_lshl_add_u32 v121, v121, 2, v122
    v_lshl_add_u32 v30, v26, 8, v30
    v_mul_hi_u32_u24 v122, 11184811, v121
    v_lshl_or_b32 v30, v34, 19, v30
    v_mad_i32_i24 v121, v122, s72, v121
    v_lshl_or_b32 v120, v120, 2, v122
    v_lshl_add_u32 v121, v121, 2, s73
    v_lshl_or_b32 v26, v120, 18, v121
    v_lshrrev_b32 v123, 16, v26
    ds_add_u32 v123, v3 offset:0
    v_mul_hi_u32_u24 v120, 3435974, v27
    v_mul_hi_u32_u24 v121, 5149841, v31
    v_mad_i32_i24 v27, v120, s33, v27
    v_mad_i32_i24 v31, v121, s34, v31
    v_and_b32 v122, 3, v27
    v_and_b32 v27, -4, v27
    v_lshl_add_u32 v121, v121, 2, v122
    v_lshl_add_u32 v31, v27, 8, v31
    v_mul_hi_u32_u24 v122, 11184811, v121
    v_and_b32 v27, 0x1fff0000, v34
    v_lshl_or_b32 v31, v27, 3, v31
    v_mad_i32_i24 v121, v122, s72, v121
    v_lshl_or_b32 v120, v120, 2, v122
    v_lshl_add_u32 v121, v121, 2, s73
    v_lshl_or_b32 v27, v120, 18, v121
    v_lshrrev_b32 v124, 16, v27
    ds_add_u32 v124, v3 offset:0
    v_mul_hi_u32_u24 v120, 3435974, v28
    v_mul_hi_u32_u24 v121, 5149841, v32
    v_mad_i32_i24 v28, v120, s33, v28
    v_mad_i32_i24 v32, v121, s34, v32
    v_and_b32 v122, 3, v28
    v_and_b32 v28, -4, v28
    v_lshl_add_u32 v121, v121, 2, v122
    v_lshl_add_u32 v32, v28, 8, v32
    v_mul_hi_u32_u24 v122, 11184811, v121
    v_lshl_or_b32 v32, v35, 19, v32
    v_mad_i32_i24 v121, v122, s72, v121
    v_lshl_or_b32 v120, v120, 2, v122
    v_lshl_add_u32 v121, v121, 2, s73
    v_lshl_or_b32 v28, v120, 18, v121
    v_lshrrev_b32 v125, 16, v28
    ds_add_u32 v125, v3 offset:0
    v_mul_hi_u32_u24 v120, 3435974, v29
    v_mul_hi_u32_u24 v121, 5149841, v33
    v_mad_i32_i24 v29, v120, s33, v29
    v_mad_i32_i24 v33, v121, s34, v33
    v_and_b32 v122, 3, v29
    v_and_b32 v29, -4, v29
    v_lshl_add_u32 v121, v121, 2, v122
    v_lshl_add_u32 v33, v29, 8, v33
    v_mul_hi_u32_u24 v122, 11184811, v121
    v_and_b32 v29, 0x1fff0000, v35
    v_lshl_or_b32 v33, v29, 3, v33
    v_mad_i32_i24 v121, v122, s72, v121
    v_lshl_or_b32 v120, v120, 2, v122
    v_lshl_add_u32 v121, v121, 2, s73
    v_lshl_or_b32 v29, v120, 18, v121
    v_lshrrev_b32 v126, 16, v29
    ds_add_u32 v126, v3 offset:0
    s_waitcnt vmcnt(6)
    v_and_b32 v44, 0x7fff7fff, v44
    v_pk_max_u16 v44, v44, s35
    v_pk_min_u16 v44, v44, s36
    v_subrev_u32 v44, 0x38003800, v44
    v_and_b32 v45, 0x7fff7fff, v45
    v_pk_max_u16 v45, v45, s35
    v_pk_min_u16 v45, v45, s36
    v_subrev_u32 v45, 0x38003800, v45
    v_mul_hi_u32_u24 v120, 3435974, v36
    v_mul_hi_u32_u24 v121, 5149841, v40
    v_mad_i32_i24 v36, v120, s33, v36
    v_mad_i32_i24 v40, v121, s34, v40
    v_and_b32 v122, 3, v36
    v_and_b32 v36, -4, v36
    v_lshl_add_u32 v121, v121, 2, v122
    v_lshl_add_u32 v40, v36, 8, v40
    v_mul_hi_u32_u24 v122, 11184811, v121
    v_lshl_or_b32 v40, v44, 19, v40
    v_mad_i32_i24 v121, v122, s72, v121
    v_lshl_or_b32 v120, v120, 2, v122
    v_lshl_add_u32 v121, v121, 2, s73
    v_lshl_or_b32 v36, v120, 18, v121
    v_lshrrev_b32 v123, 16, v36
    ds_add_u32 v123, v3 offset:0
    v_mul_hi_u32_u24 v120, 3435974, v37
    v_mul_hi_u32_u24 v121, 5149841, v41
    v_mad_i32_i24 v37, v120, s33, v37
    v_mad_i32_i24 v41, v121, s34, v41
    v_and_b32 v122, 3, v37
    v_and_b32 v37, -4, v37
    v_lshl_add_u32 v121, v121, 2, v122
    v_lshl_add_u32 v41, v37, 8, v41
    v_mul_hi_u32_u24 v122, 11184811, v121
    v_and_b32 v37, 0x1fff0000, v44
    v_lshl_or_b32 v41, v37, 3, v41
    v_mad_i32_i24 v121, v122, s72, v121
    v_lshl_or_b32 v120, v120, 2, v122
    v_lshl_add_u32 v121, v121, 2, s73
    v_lshl_or_b32 v37, v120, 18, v121
    v_lshrrev_b32 v124, 16, v37
    ds_add_u32 v124, v3 offset:0
    v_mul_hi_u32_u24 v120, 3435974, v38
    v_mul_hi_u32_u24 v121, 5149841, v42
    v_mad_i32_i24 v38, v120, s33, v38
    v_mad_i32_i24 v42, v121, s34, v42
    v_and_b32 v122, 3, v38
    v_and_b32 v38, -4, v38
    v_lshl_add_u32 v121, v121, 2, v122
    v_lshl_add_u32 v42, v38, 8, v42
    v_mul_hi_u32_u24 v122, 11184811, v121
    v_lshl_or_b32 v42, v45, 19, v42
    v_mad_i32_i24 v121, v122, s72, v121
    v_lshl_or_b32 v120, v120, 2, v122
    v_lshl_add_u32 v121, v121, 2, s73
    v_lshl_or_b32 v38, v120, 18, v121
    v_lshrrev_b32 v125, 16, v38
    ds_add_u32 v125, v3 offset:0
    v_mul_hi_u32_u24 v120, 3435974, v39
    v_mul_hi_u32_u24 v121, 5149841, v43
    v_mad_i32_i24 v39, v120, s33, v39
    v_mad_i32_i24 v43, v121, s34, v43
    v_and_b32 v122, 3, v39
    v_and_b32 v39, -4, v39
    v_lshl_add_u32 v121, v121, 2, v122
    v_lshl_add_u32 v43, v39, 8, v43
    v_mul_hi_u32_u24 v122, 11184811, v121
    v_and_b32 v39, 0x1fff0000, v45
    v_lshl_or_b32 v43, v39, 3, v43
    v_mad_i32_i24 v121, v122, s72, v121
    v_lshl_or_b32 v120, v120, 2, v122
    v_lshl_add_u32 v121, v121, 2, s73
    v_lshl_or_b32 v39, v120, 18, v121
    v_lshrrev_b32 v126, 16, v39
    ds_add_u32 v126, v3 offset:0
    s_waitcnt vmcnt(3)
    v_and_b32 v54, 0x7fff7fff, v54
    v_pk_max_u16 v54, v54, s35
    v_pk_min_u16 v54, v54, s36
    v_subrev_u32 v54, 0x38003800, v54
    v_and_b32 v55, 0x7fff7fff, v55
    v_pk_max_u16 v55, v55, s35
    v_pk_min_u16 v55, v55, s36
    v_subrev_u32 v55, 0x38003800, v55
    v_mul_hi_u32_u24 v120, 3435974, v46
    v_mul_hi_u32_u24 v121, 5149841, v50
    v_mad_i32_i24 v46, v120, s33, v46
    v_mad_i32_i24 v50, v121, s34, v50
    v_and_b32 v122, 3, v46
    v_and_b32 v46, -4, v46
    v_lshl_add_u32 v121, v121, 2, v122
    v_lshl_add_u32 v50, v46, 8, v50
    v_mul_hi_u32_u24 v122, 11184811, v121
    v_lshl_or_b32 v50, v54, 19, v50
    v_mad_i32_i24 v121, v122, s72, v121
    v_lshl_or_b32 v120, v120, 2, v122
    v_lshl_add_u32 v121, v121, 2, s73
    v_lshl_or_b32 v46, v120, 18, v121
    v_lshrrev_b32 v123, 16, v46
    ds_add_u32 v123, v3 offset:0
    v_mul_hi_u32_u24 v120, 3435974, v47
    v_mul_hi_u32_u24 v121, 5149841, v51
    v_mad_i32_i24 v47, v120, s33, v47
    v_mad_i32_i24 v51, v121, s34, v51
    v_and_b32 v122, 3, v47
    v_and_b32 v47, -4, v47
    v_lshl_add_u32 v121, v121, 2, v122
    v_lshl_add_u32 v51, v47, 8, v51
    v_mul_hi_u32_u24 v122, 11184811, v121
    v_and_b32 v47, 0x1fff0000, v54
    v_lshl_or_b32 v51, v47, 3, v51
    v_mad_i32_i24 v121, v122, s72, v121
    v_lshl_or_b32 v120, v120, 2, v122
    v_lshl_add_u32 v121, v121, 2, s73
    v_lshl_or_b32 v47, v120, 18, v121
    v_lshrrev_b32 v124, 16, v47
    ds_add_u32 v124, v3 offset:0
    v_mul_hi_u32_u24 v120, 3435974, v48
    v_mul_hi_u32_u24 v121, 5149841, v52
    v_mad_i32_i24 v48, v120, s33, v48
    v_mad_i32_i24 v52, v121, s34, v52
    v_and_b32 v122, 3, v48
    v_and_b32 v48, -4, v48
    v_lshl_add_u32 v121, v121, 2, v122
    v_lshl_add_u32 v52, v48, 8, v52
    v_mul_hi_u32_u24 v122, 11184811, v121
    v_lshl_or_b32 v52, v55, 19, v52
    v_mad_i32_i24 v121, v122, s72, v121
    v_lshl_or_b32 v120, v120, 2, v122
    v_lshl_add_u32 v121, v121, 2, s73
    v_lshl_or_b32 v48, v120, 18, v121
    v_lshrrev_b32 v125, 16, v48
    ds_add_u32 v125, v3 offset:0
    v_mul_hi_u32_u24 v120, 3435974, v49
    v_mul_hi_u32_u24 v121, 5149841, v53
    v_mad_i32_i24 v49, v120, s33, v49
    v_mad_i32_i24 v53, v121, s34, v53
    v_and_b32 v122, 3, v49
    v_and_b32 v49, -4, v49
    v_lshl_add_u32 v121, v121, 2, v122
    v_lshl_add_u32 v53, v49, 8, v53
    v_mul_hi_u32_u24 v122, 11184811, v121
    v_and_b32 v49, 0x1fff0000, v55
    v_lshl_or_b32 v53, v49, 3, v53
    v_mad_i32_i24 v121, v122, s72, v121
    v_lshl_or_b32 v120, v120, 2, v122
    v_lshl_add_u32 v121, v121, 2, s73
    v_lshl_or_b32 v49, v120, 18, v121
    v_lshrrev_b32 v126, 16, v49
    ds_add_u32 v126, v3 offset:0
    s_waitcnt vmcnt(0)
    v_and_b32 v64, 0x7fff7fff, v64
    v_pk_max_u16 v64, v64, s35
    v_pk_min_u16 v64, v64, s36
    v_subrev_u32 v64, 0x38003800, v64
    v_and_b32 v65, 0x7fff7fff, v65
    v_pk_max_u16 v65, v65, s35
    v_pk_min_u16 v65, v65, s36
    v_subrev_u32 v65, 0x38003800, v65
    v_mul_hi_u32_u24 v120, 3435974, v56
    v_mul_hi_u32_u24 v121, 5149841, v60
    v_mad_i32_i24 v56, v120, s33, v56
    v_mad_i32_i24 v60, v121, s34, v60
    v_and_b32 v122, 3, v56
    v_and_b32 v56, -4, v56
    v_lshl_add_u32 v121, v121, 2, v122
    v_lshl_add_u32 v60, v56, 8, v60
    v_mul_hi_u32_u24 v122, 11184811, v121
    v_lshl_or_b32 v60, v64, 19, v60
    v_mad_i32_i24 v121, v122, s72, v121
    v_lshl_or_b32 v120, v120, 2, v122
    v_lshl_add_u32 v121, v121, 2, s73
    v_lshl_or_b32 v56, v120, 18, v121
    v_lshrrev_b32 v123, 16, v56
    ds_add_u32 v123, v3 offset:0
    v_mul_hi_u32_u24 v120, 3435974, v57
    v_mul_hi_u32_u24 v121, 5149841, v61
    v_mad_i32_i24 v57, v120, s33, v57
    v_mad_i32_i24 v61, v121, s34, v61
    v_and_b32 v122, 3, v57
    v_and_b32 v57, -4, v57
    v_lshl_add_u32 v121, v121, 2, v122
    v_lshl_add_u32 v61, v57, 8, v61
    v_mul_hi_u32_u24 v122, 11184811, v121
    v_and_b32 v57, 0x1fff0000, v64
    v_lshl_or_b32 v61, v57, 3, v61
    v_mad_i32_i24 v121, v122, s72, v121
    v_lshl_or_b32 v120, v120, 2, v122
    v_lshl_add_u32 v121, v121, 2, s73
    v_lshl_or_b32 v57, v120, 18, v121
    v_lshrrev_b32 v124, 16, v57
    ds_add_u32 v124, v3 offset:0
    v_mul_hi_u32_u24 v120, 3435974, v58
    v_mul_hi_u32_u24 v121, 5149841, v62
    v_mad_i32_i24 v58, v120, s33, v58
    v_mad_i32_i24 v62, v121, s34, v62
    v_and_b32 v122, 3, v58
    v_and_b32 v58, -4, v58
    v_lshl_add_u32 v121, v121, 2, v122
    v_lshl_add_u32 v62, v58, 8, v62
    v_mul_hi_u32_u24 v122, 11184811, v121
    v_lshl_or_b32 v62, v65, 19, v62
    v_mad_i32_i24 v121, v122, s72, v121
    v_lshl_or_b32 v120, v120, 2, v122
    v_lshl_add_u32 v121, v121, 2, s73
    v_lshl_or_b32 v58, v120, 18, v121
    v_lshrrev_b32 v125, 16, v58
    ds_add_u32 v125, v3 offset:0
    v_mul_hi_u32_u24 v120, 3435974, v59
    v_mul_hi_u32_u24 v121, 5149841, v63
    v_mad_i32_i24 v59, v120, s33, v59
    v_mad_i32_i24 v63, v121, s34, v63
    v_and_b32 v122, 3, v59
    v_and_b32 v59, -4, v59
    v_lshl_add_u32 v121, v121, 2, v122
    v_lshl_add_u32 v63, v59, 8, v63
    v_mul_hi_u32_u24 v122, 11184811, v121
    v_and_b32 v59, 0x1fff0000, v65
    v_lshl_or_b32 v63, v59, 3, v63
    v_mad_i32_i24 v121, v122, s72, v121
    v_lshl_or_b32 v120, v120, 2, v122
    v_lshl_add_u32 v121, v121, 2, s73
    v_lshl_or_b32 v59, v120, 18, v121
    v_lshrrev_b32 v126, 16, v59
    ds_add_u32 v126, v3 offset:0
    s_add_u32 s32, s30, 20480000
    buffer_load_dwordx4 v[66:69], v1, s[12:15], s32 offen nt
    buffer_load_dwordx4 v[70:73], v1, s[8:11], s32 offen nt
    s_add_u32 s32, s31, 10240000
    buffer_load_dwordx2 v[74:75], v2, s[16:19], s32 offen nt
    s_waitcnt lgkmcnt(0)
    s_barrier
    s_cmp_ge_u32 s37, 4
    s_cbranch_scc1 part_p0a
    ds_read_b128 v[116:119], v1 offset:0
    s_lshl_b32 s48, s37, 3
    v_mov_b32 v124, s48
    s_waitcnt lgkmcnt(0)
    v_add_u32 v116, 2, v116
    v_add_u32 v117, 2, v117
    v_add_u32 v118, 2, v118
    v_add_u32 v119, 2, v119
    v_mul_u32_u24 v116, v4, v116
    v_mul_u32_u24 v117, v4, v117
    v_mul_u32_u24 v118, v4, v118
    v_mul_u32_u24 v119, v4, v119
    v_lshrrev_b32 v116, 16, v116
    v_lshrrev_b32 v117, 16, v117
    v_lshrrev_b32 v118, 16, v118
    v_lshrrev_b32 v119, 16, v119
    v_lshl_or_b32 v120, v117, 16, v116
    v_lshl_or_b32 v121, v119, 16, v118
    v_mov_b32 v122, v120
    v_mov_b32 v123, v121
    s_nop 0
    v_add_u32_dpp v122, v122, v122 row_shr:1 row_mask:0xf bank_mask:0xf
    v_add_u32_dpp v123, v123, v123 row_shr:1 row_mask:0xf bank_mask:0xf
    s_nop 0
    v_add_u32_dpp v122, v122, v122 row_shr:2 row_mask:0xf bank_mask:0xf
    v_add_u32_dpp v123, v123, v123 row_shr:2 row_mask:0xf bank_mask:0xf
    s_nop 0
    v_add_u32_dpp v122, v122, v122 row_shr:4 row_mask:0xf bank_mask:0xf
    v_add_u32_dpp v123, v123, v123 row_shr:4 row_mask:0xf bank_mask:0xf
    s_nop 0
    v_add_u32_dpp v122, v122, v122 row_shr:8 row_mask:0xf bank_mask:0xf
    v_add_u32_dpp v123, v123, v123 row_shr:8 row_mask:0xf bank_mask:0xf
    s_nop 0
    v_add_u32_dpp v122, v122, v122 row_bcast:15 row_mask:0xa bank_mask:0xf
    v_add_u32_dpp v123, v123, v123 row_bcast:15 row_mask:0xa bank_mask:0xf
    s_nop 0
    v_add_u32_dpp v122, v122, v122 row_bcast:31 row_mask:0xc bank_mask:0xf
    v_add_u32_dpp v123, v123, v123 row_bcast:31 row_mask:0xc bank_mask:0xf
    s_mov_b32 exec_lo, 0
    s_brev_b32 exec_hi, 1
    ds_write_b64 v124, v[122:123] offset:8192
    s_mov_b64 exec, -1
part_p0a:
    s_add_u32 s48, s2, 0
    s_mul_i32 s49, s48, 120192
    s_add_u32 s20, s28, s49
    s_addc_u32 s21, s29, 0
    s_mov_b32 s23, 0x20000
    s_lshl_b32 s49, s48, 12
    s_add_u32 s49, s49, 0x3c00000
    s_add_u32 s24, s28, s49
    s_addc_u32 s25, s29, 0
    s_mov_b32 s26, 4096
    s_mov_b32 s27, 0x20000
    v_mov_b32 v8, 0
    s_waitcnt lgkmcnt(0)
    s_barrier
    ds_read_b128 v[12:15], v8 offset:8208
    ds_read_b128 v[8:11], v8 offset:8192
    s_waitcnt lgkmcnt(0)
    v_readfirstlane_b32 s40, v8
    v_readfirstlane_b32 s41, v9
    v_readfirstlane_b32 s42, v10
    v_readfirstlane_b32 s43, v11
    v_readfirstlane_b32 s44, v12
    v_readfirstlane_b32 s45, v13
    v_readfirstlane_b32 s46, v14
    v_readfirstlane_b32 s47, v15
    s_add_u32 s48, s40, s42
    s_add_u32 s48, s48, s44
    s_add_u32 s48, s48, s46
    s_add_u32 s49, s41, s43
    s_add_u32 s49, s49, s45
    s_add_u32 s49, s49, s47
    s_and_b32 s52, s48, 0xffff
    s_lshr_b32 s53, s48, 16
    s_add_u32 s53, s53, s52
    s_and_b32 s54, s49, 0xffff
    s_add_u32 s54, s54, s53
    s_cmp_ge_u32 s37, 4
    s_cbranch_scc1 part_p0b
    s_lshl_b32 s50, s52, 16
    s_lshl_b32 s51, s54, 16
    s_or_b32 s51, s51, s53
    s_cmp_gt_u32 s37, 0
    s_cselect_b32 s56, s40, 0
    s_cselect_b32 s57, s41, 0
    s_add_u32 s50, s50, s56
    s_add_u32 s51, s51, s57
    s_cmp_gt_u32 s37, 1
    s_cselect_b32 s56, s42, 0
    s_cselect_b32 s57, s43, 0
    s_add_u32 s50, s50, s56
    s_add_u32 s51, s51, s57
    s_cmp_gt_u32 s37, 2
    s_cselect_b32 s56, s44, 0
    s_cselect_b32 s57, s45, 0
    s_add_u32 s50, s50, s56
    s_add_u32 s51, s51, s57
    v_sub_u32 v122, v122, v120
    v_sub_u32 v123, v123, v121
    v_add_u32 v122, s50, v122
    v_add_u32 v123, s51, v123
    v_lshlrev_b32 v8, 16, v122
    v_and_b32 v9, 0xffff0000, v122
    v_lshlrev_b32 v10, 16, v123
    v_and_b32 v11, 0xffff0000, v123
    ds_write_b128 v1, v[8:11] offset:0
    v_or_b32 v124, v8, v116
    v_or_b32 v125, v9, v117
    v_or_b32 v126, v10, v118
    v_or_b32 v127, v11, v119
    s_waitcnt lgkmcnt(0)
part_p0b:
    s_barrier
    s_lshr_b32 s55, s49, 16
    s_add_u32 s55, s55, s54
    s_lshl_b32 s22, s55, 4
    s_add_u32 s22, s22, 127
    s_and_b32 s22, s22, -128
    v_lshrrev_b32 v8, 16, v16
    ds_add_rtn_u32 v8, v8, v4 offset:0
    v_and_b32 v16, 0xfff, v16
    v_lshrrev_b32 v9, 16, v17
    ds_add_rtn_u32 v9, v9, v4 offset:0
    v_and_b32 v17, 0xfff, v17
    v_lshrrev_b32 v10, 16, v18
    ds_add_rtn_u32 v10, v10, v4 offset:0
    v_and_b32 v18, 0xfff, v18
    v_lshrrev_b32 v11, 16, v19
    ds_add_rtn_u32 v11, v11, v4 offset:0
    v_and_b32 v19, 0xfff, v19
    v_lshrrev_b32 v12, 16, v26
    ds_add_rtn_u32 v12, v12, v4 offset:0
    v_and_b32 v26, 0xfff, v26
    v_lshrrev_b32 v13, 16, v27
    ds_add_rtn_u32 v13, v13, v4 offset:0
    v_and_b32 v27, 0xfff, v27
    v_lshrrev_b32 v14, 16, v28
    ds_add_rtn_u32 v14, v14, v4 offset:0
    v_and_b32 v28, 0xfff, v28
    v_lshrrev_b32 v15, 16, v29
    ds_add_rtn_u32 v15, v15, v4 offset:0
    v_and_b32 v29, 0xfff, v29
    s_waitcnt lgkmcnt(4)
    v_mul_hi_u32 v117, v8, s77
    v_lshrrev_b32 v116, 14, v8
    v_and_b32 v8, 0xffff, v8
    v_and_b32 v117, -4, v117
    v_mul_hi_u32_u24 v8, 196608, v8
    ds_write_b32 v117, v20 offset:38368
    v_and_b32 v116, -4, v116
    v_mul_u32_u24 v8, 10, v8
    v_lshlrev_b32 v8, v8, v16
    ds_add_u32 v116, v8 offset:8320
    v_mul_hi_u32 v119, v9, s77
    v_lshrrev_b32 v118, 14, v9
    v_and_b32 v9, 0xffff, v9
    v_and_b32 v119, -4, v119
    v_mul_hi_u32_u24 v9, 196608, v9
    ds_write_b32 v119, v21 offset:38368
    v_and_b32 v118, -4, v118
    v_mul_u32_u24 v9, 10, v9
    v_lshlrev_b32 v9, v9, v17
    ds_add_u32 v118, v9 offset:8320
    v_mul_hi_u32 v117, v10, s77
    v_lshrrev_b32 v116, 14, v10
    v_and_b32 v10, 0xffff, v10
    v_and_b32 v117, -4, v117
    v_mul_hi_u32_u24 v10, 196608, v10
    ds_write_b32 v117, v22 offset:38368
    v_and_b32 v116, -4, v116
    v_mul_u32_u24 v10, 10, v10
    v_lshlrev_b32 v10, v10, v18
    ds_add_u32 v116, v10 offset:8320
    v_mul_hi_u32 v119, v11, s77
    v_lshrrev_b32 v118, 14, v11
    v_and_b32 v11, 0xffff, v11
    v_and_b32 v119, -4, v119
    v_mul_hi_u32_u24 v11, 196608, v11
    ds_write_b32 v119, v23 offset:38368
    v_and_b32 v118, -4, v118
    v_mul_u32_u24 v11, 10, v11
    v_lshlrev_b32 v11, v11, v19
    ds_add_u32 v118, v11 offset:8320
    buffer_store_dwordx4 v[124:127], v1, s[24:27], 0 offen sc1
    s_nop 1
    s_add_u32 s32, s30, 24576000
    buffer_load_dwordx4 v[76:79], v1, s[12:15], s32 offen nt
    buffer_load_dwordx4 v[80:83], v1, s[8:11], s32 offen nt
    s_add_u32 s32, s31, 12288000
    buffer_load_dwordx2 v[84:85], v2, s[16:19], s32 offen nt
    v_lshrrev_b32 v8, 16, v36
    ds_add_rtn_u32 v8, v8, v4 offset:0
    v_and_b32 v36, 0xfff, v36
    v_lshrrev_b32 v9, 16, v37
    ds_add_rtn_u32 v9, v9, v4 offset:0
    v_and_b32 v37, 0xfff, v37
    v_lshrrev_b32 v10, 16, v38
    ds_add_rtn_u32 v10, v10, v4 offset:0
    v_and_b32 v38, 0xfff, v38
    v_lshrrev_b32 v11, 16, v39
    ds_add_rtn_u32 v11, v11, v4 offset:0
    v_and_b32 v39, 0xfff, v39
    s_waitcnt lgkmcnt(12)
    v_mul_hi_u32 v117, v12, s77
    v_lshrrev_b32 v116, 14, v12
    v_and_b32 v12, 0xffff, v12
    v_and_b32 v117, -4, v117
    v_mul_hi_u32_u24 v12, 196608, v12
    ds_write_b32 v117, v30 offset:38368
    v_and_b32 v116, -4, v116
    v_mul_u32_u24 v12, 10, v12
    v_lshlrev_b32 v12, v12, v26
    ds_add_u32 v116, v12 offset:8320
    v_mul_hi_u32 v119, v13, s77
    v_lshrrev_b32 v118, 14, v13
    v_and_b32 v13, 0xffff, v13
    v_and_b32 v119, -4, v119
    v_mul_hi_u32_u24 v13, 196608, v13
    ds_write_b32 v119, v31 offset:38368
    v_and_b32 v118, -4, v118
    v_mul_u32_u24 v13, 10, v13
    v_lshlrev_b32 v13, v13, v27
    ds_add_u32 v118, v13 offset:8320
    v_mul_hi_u32 v117, v14, s77
    v_lshrrev_b32 v116, 14, v14
    v_and_b32 v14, 0xffff, v14
    v_and_b32 v117, -4, v117
    v_mul_hi_u32_u24 v14, 196608, v14
    ds_write_b32 v117, v32 offset:38368
    v_and_b32 v116, -4, v116
    v_mul_u32_u24 v14, 10, v14
    v_lshlrev_b32 v14, v14, v28
    ds_add_u32 v116, v14 offset:8320
    v_mul_hi_u32 v119, v15, s77
    v_lshrrev_b32 v118, 14, v15
    v_and_b32 v15, 0xffff, v15
    v_and_b32 v119, -4, v119
    v_mul_hi_u32_u24 v15, 196608, v15
    ds_write_b32 v119, v33 offset:38368
    v_and_b32 v118, -4, v118
    v_mul_u32_u24 v15, 10, v15
    v_lshlrev_b32 v15, v15, v29
    ds_add_u32 v118, v15 offset:8320
    v_lshrrev_b32 v12, 16, v46
    ds_add_rtn_u32 v12, v12, v4 offset:0
    v_and_b32 v46, 0xfff, v46
    v_lshrrev_b32 v13, 16, v47
    ds_add_rtn_u32 v13, v13, v4 offset:0
    v_and_b32 v47, 0xfff, v47
    v_lshrrev_b32 v14, 16, v48
    ds_add_rtn_u32 v14, v14, v4 offset:0
    v_and_b32 v48, 0xfff, v48
    v_lshrrev_b32 v15, 16, v49
    ds_add_rtn_u32 v15, v15, v4 offset:0
    v_and_b32 v49, 0xfff, v49
    s_waitcnt lgkmcnt(12)
    v_mul_hi_u32 v117, v8, s77
    v_lshrrev_b32 v116, 14, v8
    v_and_b32 v8, 0xffff, v8
    v_and_b32 v117, -4, v117
    v_mul_hi_u32_u24 v8, 196608, v8
    ds_write_b32 v117, v40 offset:38368
    v_and_b32 v116, -4, v116
    v_mul_u32_u24 v8, 10, v8
    v_lshlrev_b32 v8, v8, v36
    ds_add_u32 v116, v8 offset:8320
    v_mul_hi_u32 v119, v9, s77
    v_lshrrev_b32 v118, 14, v9
    v_and_b32 v9, 0xffff, v9
    v_and_b32 v119, -4, v119
    v_mul_hi_u32_u24 v9, 196608, v9
    ds_write_b32 v119, v41 offset:38368
    v_and_b32 v118, -4, v118
    v_mul_u32_u24 v9, 10, v9
    v_lshlrev_b32 v9, v9, v37
    ds_add_u32 v118, v9 offset:8320
    v_mul_hi_u32 v117, v10, s77
    v_lshrrev_b32 v116, 14, v10
    v_and_b32 v10, 0xffff, v10
    v_and_b32 v117, -4, v117
    v_mul_hi_u32_u24 v10, 196608, v10
    ds_write_b32 v117, v42 offset:38368
    v_and_b32 v116, -4, v116
    v_mul_u32_u24 v10, 10, v10
    v_lshlrev_b32 v10, v10, v38
    ds_add_u32 v116, v10 offset:8320
    v_mul_hi_u32 v119, v11, s77
    v_lshrrev_b32 v118, 14, v11
    v_and_b32 v11, 0xffff, v11
    v_and_b32 v119, -4, v119
    v_mul_hi_u32_u24 v11, 196608, v11
    ds_write_b32 v119, v43 offset:38368
    v_and_b32 v118, -4, v118
    v_mul_u32_u24 v11, 10, v11
    v_lshlrev_b32 v11, v11, v39
    ds_add_u32 v118, v11 offset:8320
    s_add_u32 s32, s30, 28672000
    buffer_load_dwordx4 v[86:89], v1, s[12:15], s32 offen nt
    buffer_load_dwordx4 v[90:93], v1, s[8:11], s32 offen nt
    s_add_u32 s32, s31, 14336000
    buffer_load_dwordx2 v[94:95], v2, s[16:19], s32 offen nt
    s_waitcnt vmcnt(7)
    v_and_b32 v74, 0x7fff7fff, v74
    v_pk_max_u16 v74, v74, s35
    v_pk_min_u16 v74, v74, s36
    v_subrev_u32 v74, 0x38003800, v74
    v_and_b32 v75, 0x7fff7fff, v75
    v_pk_max_u16 v75, v75, s35
    v_pk_min_u16 v75, v75, s36
    v_subrev_u32 v75, 0x38003800, v75
    v_mul_hi_u32_u24 v120, 3435974, v66
    v_mul_hi_u32_u24 v121, 5149841, v70
    v_mad_i32_i24 v66, v120, s33, v66
    v_mad_i32_i24 v70, v121, s34, v70
    v_and_b32 v122, 3, v66
    v_and_b32 v66, -4, v66
    v_lshl_add_u32 v121, v121, 2, v122
    v_lshl_add_u32 v70, v66, 8, v70
    v_mul_hi_u32_u24 v122, 11184811, v121
    v_lshl_or_b32 v70, v74, 19, v70
    v_mad_i32_i24 v121, v122, s72, v121
    v_lshl_or_b32 v120, v120, 2, v122
    v_lshl_add_u32 v121, v121, 2, s74
    v_lshl_or_b32 v66, v120, 18, v121
    v_lshrrev_b32 v123, 16, v66
    ds_add_u32 v123, v3 offset:4096
    v_mul_hi_u32_u24 v120, 3435974, v67
    v_mul_hi_u32_u24 v121, 5149841, v71
    v_mad_i32_i24 v67, v120, s33, v67
    v_mad_i32_i24 v71, v121, s34, v71
    v_and_b32 v122, 3, v67
    v_and_b32 v67, -4, v67
    v_lshl_add_u32 v121, v121, 2, v122
    v_lshl_add_u32 v71, v67, 8, v71
    v_mul_hi_u32_u24 v122, 11184811, v121
    v_and_b32 v67, 0x1fff0000, v74
    v_lshl_or_b32 v71, v67, 3, v71
    v_mad_i32_i24 v121, v122, s72, v121
    v_lshl_or_b32 v120, v120, 2, v122
    v_lshl_add_u32 v121, v121, 2, s74
    v_lshl_or_b32 v67, v120, 18, v121
    v_lshrrev_b32 v124, 16, v67
    ds_add_u32 v124, v3 offset:4096
    v_mul_hi_u32_u24 v120, 3435974, v68
    v_mul_hi_u32_u24 v121, 5149841, v72
    v_mad_i32_i24 v68, v120, s33, v68
    v_mad_i32_i24 v72, v121, s34, v72
    v_and_b32 v122, 3, v68
    v_and_b32 v68, -4, v68
    v_lshl_add_u32 v121, v121, 2, v122
    v_lshl_add_u32 v72, v68, 8, v72
    v_mul_hi_u32_u24 v122, 11184811, v121
    v_lshl_or_b32 v72, v75, 19, v72
    v_mad_i32_i24 v121, v122, s72, v121
    v_lshl_or_b32 v120, v120, 2, v122
    v_lshl_add_u32 v121, v121, 2, s74
    v_lshl_or_b32 v68, v120, 18, v121
    v_lshrrev_b32 v125, 16, v68
    ds_add_u32 v125, v3 offset:4096
    v_mul_hi_u32_u24 v120, 3435974, v69
    v_mul_hi_u32_u24 v121, 5149841, v73
    v_mad_i32_i24 v69, v120, s33, v69
    v_mad_i32_i24 v73, v121, s34, v73
    v_and_b32 v122, 3, v69
    v_and_b32 v69, -4, v69
    v_lshl_add_u32 v121, v121, 2, v122
    v_lshl_add_u32 v73, v69, 8, v73
    v_mul_hi_u32_u24 v122, 11184811, v121
    v_and_b32 v69, 0x1fff0000, v75
    v_lshl_or_b32 v73, v69, 3, v73
    v_mad_i32_i24 v121, v122, s72, v121
    v_lshl_or_b32 v120, v120, 2, v122
    v_lshl_add_u32 v121, v121, 2, s74
    v_lshl_or_b32 v69, v120, 18, v121
    v_lshrrev_b32 v126, 16, v69
    ds_add_u32 v126, v3 offset:4096
    v_lshrrev_b32 v8, 16, v56
    ds_add_rtn_u32 v8, v8, v4 offset:0
    v_and_b32 v56, 0xfff, v56
    v_lshrrev_b32 v9, 16, v57
    ds_add_rtn_u32 v9, v9, v4 offset:0
    v_and_b32 v57, 0xfff, v57
    v_lshrrev_b32 v10, 16, v58
    ds_add_rtn_u32 v10, v10, v4 offset:0
    v_and_b32 v58, 0xfff, v58
    v_lshrrev_b32 v11, 16, v59
    ds_add_rtn_u32 v11, v11, v4 offset:0
    v_and_b32 v59, 0xfff, v59
    s_waitcnt lgkmcnt(12)
    v_mul_hi_u32 v117, v12, s77
    v_lshrrev_b32 v116, 14, v12
    v_and_b32 v12, 0xffff, v12
    v_and_b32 v117, -4, v117
    v_mul_hi_u32_u24 v12, 196608, v12
    ds_write_b32 v117, v50 offset:38368
    v_and_b32 v116, -4, v116
    v_mul_u32_u24 v12, 10, v12
    v_lshlrev_b32 v12, v12, v46
    ds_add_u32 v116, v12 offset:8320
    v_mul_hi_u32 v119, v13, s77
    v_lshrrev_b32 v118, 14, v13
    v_and_b32 v13, 0xffff, v13
    v_and_b32 v119, -4, v119
    v_mul_hi_u32_u24 v13, 196608, v13
    ds_write_b32 v119, v51 offset:38368
    v_and_b32 v118, -4, v118
    v_mul_u32_u24 v13, 10, v13
    v_lshlrev_b32 v13, v13, v47
    ds_add_u32 v118, v13 offset:8320
    v_mul_hi_u32 v117, v14, s77
    v_lshrrev_b32 v116, 14, v14
    v_and_b32 v14, 0xffff, v14
    v_and_b32 v117, -4, v117
    v_mul_hi_u32_u24 v14, 196608, v14
    ds_write_b32 v117, v52 offset:38368
    v_and_b32 v116, -4, v116
    v_mul_u32_u24 v14, 10, v14
    v_lshlrev_b32 v14, v14, v48
    ds_add_u32 v116, v14 offset:8320
    v_mul_hi_u32 v119, v15, s77
    v_lshrrev_b32 v118, 14, v15
    v_and_b32 v15, 0xffff, v15
    v_and_b32 v119, -4, v119
    v_mul_hi_u32_u24 v15, 196608, v15
    ds_write_b32 v119, v53 offset:38368
    v_and_b32 v118, -4, v118
    v_mul_u32_u24 v15, 10, v15
    v_lshlrev_b32 v15, v15, v49
    ds_add_u32 v118, v15 offset:8320
    s_waitcnt vmcnt(3)
    v_and_b32 v84, 0x7fff7fff, v84
    v_pk_max_u16 v84, v84, s35
    v_pk_min_u16 v84, v84, s36
    v_subrev_u32 v84, 0x38003800, v84
    v_and_b32 v85, 0x7fff7fff, v85
    v_pk_max_u16 v85, v85, s35
    v_pk_min_u16 v85, v85, s36
    v_subrev_u32 v85, 0x38003800, v85
    v_mul_hi_u32_u24 v120, 3435974, v76
    v_mul_hi_u32_u24 v121, 5149841, v80
    v_mad_i32_i24 v76, v120, s33, v76
    v_mad_i32_i24 v80, v121, s34, v80
    v_and_b32 v122, 3, v76
    v_and_b32 v76, -4, v76
    v_lshl_add_u32 v121, v121, 2, v122
    v_lshl_add_u32 v80, v76, 8, v80
    v_mul_hi_u32_u24 v122, 11184811, v121
    v_lshl_or_b32 v80, v84, 19, v80
    v_mad_i32_i24 v121, v122, s72, v121
    v_lshl_or_b32 v120, v120, 2, v122
    v_lshl_add_u32 v121, v121, 2, s74
    v_lshl_or_b32 v76, v120, 18, v121
    v_lshrrev_b32 v123, 16, v76
    ds_add_u32 v123, v3 offset:4096
    v_mul_hi_u32_u24 v120, 3435974, v77
    v_mul_hi_u32_u24 v121, 5149841, v81
    v_mad_i32_i24 v77, v120, s33, v77
    v_mad_i32_i24 v81, v121, s34, v81
    v_and_b32 v122, 3, v77
    v_and_b32 v77, -4, v77
    v_lshl_add_u32 v121, v121, 2, v122
    v_lshl_add_u32 v81, v77, 8, v81
    v_mul_hi_u32_u24 v122, 11184811, v121
    v_and_b32 v77, 0x1fff0000, v84
    v_lshl_or_b32 v81, v77, 3, v81
    v_mad_i32_i24 v121, v122, s72, v121
    v_lshl_or_b32 v120, v120, 2, v122
    v_lshl_add_u32 v121, v121, 2, s74
    v_lshl_or_b32 v77, v120, 18, v121
    v_lshrrev_b32 v124, 16, v77
    ds_add_u32 v124, v3 offset:4096
    v_mul_hi_u32_u24 v120, 3435974, v78
    v_mul_hi_u32_u24 v121, 5149841, v82
    v_mad_i32_i24 v78, v120, s33, v78
    v_mad_i32_i24 v82, v121, s34, v82
    v_and_b32 v122, 3, v78
    v_and_b32 v78, -4, v78
    v_lshl_add_u32 v121, v121, 2, v122
    v_lshl_add_u32 v82, v78, 8, v82
    v_mul_hi_u32_u24 v122, 11184811, v121
    v_lshl_or_b32 v82, v85, 19, v82
    v_mad_i32_i24 v121, v122, s72, v121
    v_lshl_or_b32 v120, v120, 2, v122
    v_lshl_add_u32 v121, v121, 2, s74
    v_lshl_or_b32 v78, v120, 18, v121
    v_lshrrev_b32 v125, 16, v78
    ds_add_u32 v125, v3 offset:4096
    v_mul_hi_u32_u24 v120, 3435974, v79
    v_mul_hi_u32_u24 v121, 5149841, v83
    v_mad_i32_i24 v79, v120, s33, v79
    v_mad_i32_i24 v83, v121, s34, v83
    v_and_b32 v122, 3, v79
    v_and_b32 v79, -4, v79
    v_lshl_add_u32 v121, v121, 2, v122
    v_lshl_add_u32 v83, v79, 8, v83
    v_mul_hi_u32_u24 v122, 11184811, v121
    v_and_b32 v79, 0x1fff0000, v85
    v_lshl_or_b32 v83, v79, 3, v83
    v_mad_i32_i24 v121, v122, s72, v121
    v_lshl_or_b32 v120, v120, 2, v122
    v_lshl_add_u32 v121, v121, 2, s74
    v_lshl_or_b32 v79, v120, 18, v121
    v_lshrrev_b32 v126, 16, v79
    ds_add_u32 v126, v3 offset:4096
    s_waitcnt lgkmcnt(8)
    v_mul_hi_u32 v117, v8, s77
    v_lshrrev_b32 v116, 14, v8
    v_and_b32 v8, 0xffff, v8
    v_and_b32 v117, -4, v117
    v_mul_hi_u32_u24 v8, 196608, v8
    ds_write_b32 v117, v60 offset:38368
    v_and_b32 v116, -4, v116
    v_mul_u32_u24 v8, 10, v8
    v_lshlrev_b32 v8, v8, v56
    ds_add_u32 v116, v8 offset:8320
    v_mul_hi_u32 v119, v9, s77
    v_lshrrev_b32 v118, 14, v9
    v_and_b32 v9, 0xffff, v9
    v_and_b32 v119, -4, v119
    v_mul_hi_u32_u24 v9, 196608, v9
    ds_write_b32 v119, v61 offset:38368
    v_and_b32 v118, -4, v118
    v_mul_u32_u24 v9, 10, v9
    v_lshlrev_b32 v9, v9, v57
    ds_add_u32 v118, v9 offset:8320
    v_mul_hi_u32 v117, v10, s77
    v_lshrrev_b32 v116, 14, v10
    v_and_b32 v10, 0xffff, v10
    v_and_b32 v117, -4, v117
    v_mul_hi_u32_u24 v10, 196608, v10
    ds_write_b32 v117, v62 offset:38368
    v_and_b32 v116, -4, v116
    v_mul_u32_u24 v10, 10, v10
    v_lshlrev_b32 v10, v10, v58
    ds_add_u32 v116, v10 offset:8320
    v_mul_hi_u32 v119, v11, s77
    v_lshrrev_b32 v118, 14, v11
    v_and_b32 v11, 0xffff, v11
    v_and_b32 v119, -4, v119
    v_mul_hi_u32_u24 v11, 196608, v11
    ds_write_b32 v119, v63 offset:38368
    v_and_b32 v118, -4, v118
    v_mul_u32_u24 v11, 10, v11
    v_lshlrev_b32 v11, v11, v59
    ds_add_u32 v118, v11 offset:8320
    s_add_u32 s32, s30, 32768000
    buffer_load_dwordx4 v[96:99], v1, s[12:15], s32 offen nt
    buffer_load_dwordx4 v[100:103], v1, s[8:11], s32 offen nt
    s_add_u32 s32, s31, 16384000
    buffer_load_dwordx2 v[104:105], v2, s[16:19], s32 offen nt
    s_waitcnt lgkmcnt(0)
    s_barrier
    v_add_u32 v18, 38368, v6
    ds_read2_b32 v[16:17], v18 offset0:0 offset1:1
    ds_read_b32 v18, v18 offset:8
    ds_read_b32 v19, v5 offset:8320
    v_add_u32 v22, 50656, v6
    ds_read2_b32 v[20:21], v22 offset0:0 offset1:1
    ds_read_b32 v22, v22 offset:8
    ds_read_b32 v23, v5 offset:12416
    v_add_u32 v28, 62944, v6
    ds_read2_b32 v[26:27], v28 offset0:0 offset1:1
    ds_read_b32 v28, v28 offset:8
    ds_read_b32 v29, v5 offset:16512
    v_add_u32 v32, 75232, v6
    ds_read2_b32 v[30:31], v32 offset0:0 offset1:1
    ds_read_b32 v32, v32 offset:8
    ds_read_b32 v33, v5 offset:20608
    v_add_u32 v38, 87520, v6
    ds_read2_b32 v[36:37], v38 offset0:0 offset1:1
    ds_read_b32 v38, v38 offset:8
    ds_read_b32 v39, v5 offset:24704
    v_add_u32 v42, 99808, v6
    ds_read2_b32 v[40:41], v42 offset0:0 offset1:1
    ds_read_b32 v42, v42 offset:8
    ds_read_b32 v43, v5 offset:28800
    v_add_u32 v48, 112096, v6
    ds_read2_b32 v[46:47], v48 offset0:0 offset1:1
    ds_read_b32 v48, v48 offset:8
    ds_read_b32 v49, v5 offset:32896
    v_add_u32 v52, 124384, v6
    ds_read2_b32 v[50:51], v52 offset0:0 offset1:1
    ds_read_b32 v52, v52 offset:8
    ds_read_b32 v53, v5 offset:36992
    v_mov_b32 v8, s76
    ds_write_b32 v5, v8 offset:8320
    ds_write_b32 v5, v8 offset:12416
    ds_write_b32 v5, v8 offset:16512
    ds_write_b32 v5, v8 offset:20608
    ds_write_b32 v5, v8 offset:24704
    ds_write_b32 v5, v8 offset:28800
    ds_write_b32 v5, v8 offset:32896
    v_cmp_gt_u32 vcc, 344, v0
    s_mov_b64 exec, vcc
    ds_write_b32 v5, v8 offset:36992
    s_mov_b64 exec, -1
    s_waitcnt lgkmcnt(8)
    s_add_u32 s32, s30, 36864000
    buffer_load_dwordx4 v[106:109], v1, s[12:15], s32 offen nt
    buffer_load_dwordx4 v[110:113], v1, s[8:11], s32 offen nt
    s_add_u32 s32, s31, 18432000
    buffer_load_dwordx2 v[114:115], v2, s[16:19], s32 offen nt
    s_mov_b32 s68, s64
    s_mov_b32 s69, s65
    s_mov_b32 s70, 0x271000
    s_mov_b32 s71, 0x20000
    s_mul_i32 s32, s2, 10240
    s_add_u32 s70, s32, 10240
    s_min_u32 s70, s70, 2560000
    v_lshlrev_b32 v24, 7, v0
    buffer_load_dword v25, v24, s[68:71], s32 offen
    s_mov_b32 s68, s66
    s_mov_b32 s69, s67
    s_mov_b32 s70, 0x9c400
    s_mov_b32 s71, 0x20000
    s_mul_i32 s32, s2, 2560
    s_add_u32 s70, s32, 2560
    s_min_u32 s70, s70, 640000
    buffer_load_dword v24, v24, s[68:71], s32 offen
    s_waitcnt vmcnt(8)
    v_and_b32 v94, 0x7fff7fff, v94
    v_pk_max_u16 v94, v94, s35
    v_pk_min_u16 v94, v94, s36
    v_subrev_u32 v94, 0x38003800, v94
    v_and_b32 v95, 0x7fff7fff, v95
    v_pk_max_u16 v95, v95, s35
    v_pk_min_u16 v95, v95, s36
    v_subrev_u32 v95, 0x38003800, v95
    v_mul_hi_u32_u24 v120, 3435974, v86
    v_mul_hi_u32_u24 v121, 5149841, v90
    v_mad_i32_i24 v86, v120, s33, v86
    v_mad_i32_i24 v90, v121, s34, v90
    v_and_b32 v122, 3, v86
    v_and_b32 v86, -4, v86
    v_lshl_add_u32 v121, v121, 2, v122
    v_lshl_add_u32 v90, v86, 8, v90
    v_mul_hi_u32_u24 v122, 11184811, v121
    v_lshl_or_b32 v90, v94, 19, v90
    v_mad_i32_i24 v121, v122, s72, v121
    v_lshl_or_b32 v120, v120, 2, v122
    v_lshl_add_u32 v121, v121, 2, s74
    v_lshl_or_b32 v86, v120, 18, v121
    v_lshrrev_b32 v123, 16, v86
    ds_add_u32 v123, v3 offset:4096
    v_mul_hi_u32_u24 v120, 3435974, v87
    v_mul_hi_u32_u24 v121, 5149841, v91
    v_mad_i32_i24 v87, v120, s33, v87
    v_mad_i32_i24 v91, v121, s34, v91
    v_and_b32 v122, 3, v87
    v_and_b32 v87, -4, v87
    v_lshl_add_u32 v121, v121, 2, v122
    v_lshl_add_u32 v91, v87, 8, v91
    v_mul_hi_u32_u24 v122, 11184811, v121
    v_and_b32 v87, 0x1fff0000, v94
    v_lshl_or_b32 v91, v87, 3, v91
    v_mad_i32_i24 v121, v122, s72, v121
    v_lshl_or_b32 v120, v120, 2, v122
    v_lshl_add_u32 v121, v121, 2, s74
    v_lshl_or_b32 v87, v120, 18, v121
    v_lshrrev_b32 v124, 16, v87
    ds_add_u32 v124, v3 offset:4096
    v_mul_hi_u32_u24 v120, 3435974, v88
    v_mul_hi_u32_u24 v121, 5149841, v92
    v_mad_i32_i24 v88, v120, s33, v88
    v_mad_i32_i24 v92, v121, s34, v92
    v_and_b32 v122, 3, v88
    v_and_b32 v88, -4, v88
    v_lshl_add_u32 v121, v121, 2, v122
    v_lshl_add_u32 v92, v88, 8, v92
    v_mul_hi_u32_u24 v122, 11184811, v121
    v_lshl_or_b32 v92, v95, 19, v92
    v_mad_i32_i24 v121, v122, s72, v121
    v_lshl_or_b32 v120, v120, 2, v122
    v_lshl_add_u32 v121, v121, 2, s74
    v_lshl_or_b32 v88, v120, 18, v121
    v_lshrrev_b32 v125, 16, v88
    ds_add_u32 v125, v3 offset:4096
    v_mul_hi_u32_u24 v120, 3435974, v89
    v_mul_hi_u32_u24 v121, 5149841, v93
    v_mad_i32_i24 v89, v120, s33, v89
    v_mad_i32_i24 v93, v121, s34, v93
    v_and_b32 v122, 3, v89
    v_and_b32 v89, -4, v89
    v_lshl_add_u32 v121, v121, 2, v122
    v_lshl_add_u32 v93, v89, 8, v93
    v_mul_hi_u32_u24 v122, 11184811, v121
    v_and_b32 v89, 0x1fff0000, v95
    v_lshl_or_b32 v93, v89, 3, v93
    v_mad_i32_i24 v121, v122, s72, v121
    v_lshl_or_b32 v120, v120, 2, v122
    v_lshl_add_u32 v121, v121, 2, s74
    v_lshl_or_b32 v89, v120, 18, v121
    v_lshrrev_b32 v126, 16, v89
    ds_add_u32 v126, v3 offset:4096
    s_waitcnt vmcnt(5)
    v_and_b32 v104, 0x7fff7fff, v104
    v_pk_max_u16 v104, v104, s35
    v_pk_min_u16 v104, v104, s36
    v_subrev_u32 v104, 0x38003800, v104
    v_and_b32 v105, 0x7fff7fff, v105
    v_pk_max_u16 v105, v105, s35
    v_pk_min_u16 v105, v105, s36
    v_subrev_u32 v105, 0x38003800, v105
    v_mul_hi_u32_u24 v120, 3435974, v96
    v_mul_hi_u32_u24 v121, 5149841, v100
    v_mad_i32_i24 v96, v120, s33, v96
    v_mad_i32_i24 v100, v121, s34, v100
    v_and_b32 v122, 3, v96
    v_and_b32 v96, -4, v96
    v_lshl_add_u32 v121, v121, 2, v122
    v_lshl_add_u32 v100, v96, 8, v100
    v_mul_hi_u32_u24 v122, 11184811, v121
    v_lshl_or_b32 v100, v104, 19, v100
    v_mad_i32_i24 v121, v122, s72, v121
    v_lshl_or_b32 v120, v120, 2, v122
    v_lshl_add_u32 v121, v121, 2, s74
    v_lshl_or_b32 v96, v120, 18, v121
    v_lshrrev_b32 v123, 16, v96
    ds_add_u32 v123, v3 offset:4096
    v_mul_hi_u32_u24 v120, 3435974, v97
    v_mul_hi_u32_u24 v121, 5149841, v101
    v_mad_i32_i24 v97, v120, s33, v97
    v_mad_i32_i24 v101, v121, s34, v101
    v_and_b32 v122, 3, v97
    v_and_b32 v97, -4, v97
    v_lshl_add_u32 v121, v121, 2, v122
    v_lshl_add_u32 v101, v97, 8, v101
    v_mul_hi_u32_u24 v122, 11184811, v121
    v_and_b32 v97, 0x1fff0000, v104
    v_lshl_or_b32 v101, v97, 3, v101
    v_mad_i32_i24 v121, v122, s72, v121
    v_lshl_or_b32 v120, v120, 2, v122
    v_lshl_add_u32 v121, v121, 2, s74
    v_lshl_or_b32 v97, v120, 18, v121
    v_lshrrev_b32 v124, 16, v97
    ds_add_u32 v124, v3 offset:4096
    v_mul_hi_u32_u24 v120, 3435974, v98
    v_mul_hi_u32_u24 v121, 5149841, v102
    v_mad_i32_i24 v98, v120, s33, v98
    v_mad_i32_i24 v102, v121, s34, v102
    v_and_b32 v122, 3, v98
    v_and_b32 v98, -4, v98
    v_lshl_add_u32 v121, v121, 2, v122
    v_lshl_add_u32 v102, v98, 8, v102
    v_mul_hi_u32_u24 v122, 11184811, v121
    v_lshl_or_b32 v102, v105, 19, v102
    v_mad_i32_i24 v121, v122, s72, v121
    v_lshl_or_b32 v120, v120, 2, v122
    v_lshl_add_u32 v121, v121, 2, s74
    v_lshl_or_b32 v98, v120, 18, v121
    v_lshrrev_b32 v125, 16, v98
    ds_add_u32 v125, v3 offset:4096
    v_mul_hi_u32_u24 v120, 3435974, v99
    v_mul_hi_u32_u24 v121, 5149841, v103
    v_mad_i32_i24 v99, v120, s33, v99
    v_mad_i32_i24 v103, v121, s34, v103
    v_and_b32 v122, 3, v99
    v_and_b32 v99, -4, v99
    v_lshl_add_u32 v121, v121, 2, v122
    v_lshl_add_u32 v103, v99, 8, v103
    v_mul_hi_u32_u24 v122, 11184811, v121
    v_and_b32 v99, 0x1fff0000, v105
    v_lshl_or_b32 v103, v99, 3, v103
    v_mad_i32_i24 v121, v122, s72, v121
    v_lshl_or_b32 v120, v120, 2, v122
    v_lshl_add_u32 v121, v121, 2, s74
    v_lshl_or_b32 v99, v120, 18, v121
    v_lshrrev_b32 v126, 16, v99
    ds_add_u32 v126, v3 offset:4096
    s_waitcnt vmcnt(2)
    v_and_b32 v114, 0x7fff7fff, v114
    v_pk_max_u16 v114, v114, s35
    v_pk_min_u16 v114, v114, s36
    v_subrev_u32 v114, 0x38003800, v114
    v_and_b32 v115, 0x7fff7fff, v115
    v_pk_max_u16 v115, v115, s35
    v_pk_min_u16 v115, v115, s36
    v_subrev_u32 v115, 0x38003800, v115
    v_mul_hi_u32_u24 v120, 3435974, v106
    v_mul_hi_u32_u24 v121, 5149841, v110
    v_mad_i32_i24 v106, v120, s33, v106
    v_mad_i32_i24 v110, v121, s34, v110
    v_and_b32 v122, 3, v106
    v_and_b32 v106, -4, v106
    v_lshl_add_u32 v121, v121, 2, v122
    v_lshl_add_u32 v110, v106, 8, v110
    v_mul_hi_u32_u24 v122, 11184811, v121
    v_lshl_or_b32 v110, v114, 19, v110
    v_mad_i32_i24 v121, v122, s72, v121
    v_lshl_or_b32 v120, v120, 2, v122
    v_lshl_add_u32 v121, v121, 2, s74
    v_lshl_or_b32 v106, v120, 18, v121
    v_lshrrev_b32 v123, 16, v106
    ds_add_u32 v123, v3 offset:4096
    v_mul_hi_u32_u24 v120, 3435974, v107
    v_mul_hi_u32_u24 v121, 5149841, v111
    v_mad_i32_i24 v107, v120, s33, v107
    v_mad_i32_i24 v111, v121, s34, v111
    v_and_b32 v122, 3, v107
    v_and_b32 v107, -4, v107
    v_lshl_add_u32 v121, v121, 2, v122
    v_lshl_add_u32 v111, v107, 8, v111
    v_mul_hi_u32_u24 v122, 11184811, v121
    v_and_b32 v107, 0x1fff0000, v114
    v_lshl_or_b32 v111, v107, 3, v111
    v_mad_i32_i24 v121, v122, s72, v121
    v_lshl_or_b32 v120, v120, 2, v122
    v_lshl_add_u32 v121, v121, 2, s74
    v_lshl_or_b32 v107, v120, 18, v121
    v_lshrrev_b32 v124, 16, v107
    ds_add_u32 v124, v3 offset:4096
    v_mul_hi_u32_u24 v120, 3435974, v108
    v_mul_hi_u32_u24 v121, 5149841, v112
    v_mad_i32_i24 v108, v120, s33, v108
    v_mad_i32_i24 v112, v121, s34, v112
    v_and_b32 v122, 3, v108
    v_and_b32 v108, -4, v108
    v_lshl_add_u32 v121, v121, 2, v122
    v_lshl_add_u32 v112, v108, 8, v112
    v_mul_hi_u32_u24 v122, 11184811, v121
    v_lshl_or_b32 v112, v115, 19, v112
    v_mad_i32_i24 v121, v122, s72, v121
    v_lshl_or_b32 v120, v120, 2, v122
    v_lshl_add_u32 v121, v121, 2, s74
    v_lshl_or_b32 v108, v120, 18, v121
    v_lshrrev_b32 v125, 16, v108
    ds_add_u32 v125, v3 offset:4096
    v_mul_hi_u32_u24 v120, 3435974, v109
    v_mul_hi_u32_u24 v121, 5149841, v113
    v_mad_i32_i24 v109, v120, s33, v109
    v_mad_i32_i24 v113, v121, s34, v113
    v_and_b32 v122, 3, v109
    v_and_b32 v109, -4, v109
    v_lshl_add_u32 v121, v121, 2, v122
    v_lshl_add_u32 v113, v109, 8, v113
    v_mul_hi_u32_u24 v122, 11184811, v121
    v_and_b32 v109, 0x1fff0000, v115
    v_lshl_or_b32 v113, v109, 3, v113
    v_mad_i32_i24 v121, v122, s72, v121
    v_lshl_or_b32 v120, v120, 2, v122
    v_lshl_add_u32 v121, v121, 2, s74
    v_lshl_or_b32 v109, v120, 18, v121
    v_lshrrev_b32 v126, 16, v109
    ds_add_u32 v126, v3 offset:4096
    s_waitcnt lgkmcnt(0)
    s_barrier
    s_cmp_ge_u32 s37, 4
    s_cbranch_scc1 part_p1a
    ds_read_b128 v[116:119], v1 offset:4096
    s_lshl_b32 s48, s37, 3
    v_mov_b32 v124, s48
    s_waitcnt lgkmcnt(0)
    v_add_u32 v116, 2, v116
    v_add_u32 v117, 2, v117
    v_add_u32 v118, 2, v118
    v_add_u32 v119, 2, v119
    v_mul_u32_u24 v116, v4, v116
    v_mul_u32_u24 v117, v4, v117
    v_mul_u32_u24 v118, v4, v118
    v_mul_u32_u24 v119, v4, v119
    v_lshrrev_b32 v116, 16, v116
    v_lshrrev_b32 v117, 16, v117
    v_lshrrev_b32 v118, 16, v118
    v_lshrrev_b32 v119, 16, v119
    v_lshl_or_b32 v120, v117, 16, v116
    v_lshl_or_b32 v121, v119, 16, v118
    v_mov_b32 v122, v120
    v_mov_b32 v123, v121
    s_nop 0
    v_add_u32_dpp v122, v122, v122 row_shr:1 row_mask:0xf bank_mask:0xf
    v_add_u32_dpp v123, v123, v123 row_shr:1 row_mask:0xf bank_mask:0xf
    s_nop 0
    v_add_u32_dpp v122, v122, v122 row_shr:2 row_mask:0xf bank_mask:0xf
    v_add_u32_dpp v123, v123, v123 row_shr:2 row_mask:0xf bank_mask:0xf
    s_nop 0
    v_add_u32_dpp v122, v122, v122 row_shr:4 row_mask:0xf bank_mask:0xf
    v_add_u32_dpp v123, v123, v123 row_shr:4 row_mask:0xf bank_mask:0xf
    s_nop 0
    v_add_u32_dpp v122, v122, v122 row_shr:8 row_mask:0xf bank_mask:0xf
    v_add_u32_dpp v123, v123, v123 row_shr:8 row_mask:0xf bank_mask:0xf
    s_nop 0
    v_add_u32_dpp v122, v122, v122 row_bcast:15 row_mask:0xa bank_mask:0xf
    v_add_u32_dpp v123, v123, v123 row_bcast:15 row_mask:0xa bank_mask:0xf
    s_nop 0
    v_add_u32_dpp v122, v122, v122 row_bcast:31 row_mask:0xc bank_mask:0xf
    v_add_u32_dpp v123, v123, v123 row_bcast:31 row_mask:0xc bank_mask:0xf
    s_mov_b32 exec_lo, 0
    s_brev_b32 exec_hi, 1
    ds_write_b64 v124, v[122:123] offset:8192
    s_mov_b64 exec, -1
part_p1a:
    s_add_u32 s48, s2, 250
    s_mul_i32 s49, s48, 120192
    s_add_u32 s60, s28, s49
    s_addc_u32 s61, s29, 0
    s_mov_b32 s63, 0x20000
    s_lshl_b32 s49, s48, 12
    s_add_u32 s49, s49, 0x3c00000
    s_add_u32 s24, s28, s49
    s_addc_u32 s25, s29, 0
    s_mov_b32 s26, 4096
    s_mov_b32 s27, 0x20000
    v_mov_b32 v8, 0
    s_waitcnt lgkmcnt(0)
    s_barrier
    ds_read_b128 v[12:15], v8 offset:8208
    ds_read_b128 v[8:11], v8 offset:8192
    s_waitcnt lgkmcnt(0)
    v_readfirstlane_b32 s40, v8
    v_readfirstlane_b32 s41, v9
    v_readfirstlane_b32 s42, v10
    v_readfirstlane_b32 s43, v11
    v_readfirstlane_b32 s44, v12
    v_readfirstlane_b32 s45, v13
    v_readfirstlane_b32 s46, v14
    v_readfirstlane_b32 s47, v15
    s_add_u32 s48, s40, s42
    s_add_u32 s48, s48, s44
    s_add_u32 s48, s48, s46
    s_add_u32 s49, s41, s43
    s_add_u32 s49, s49, s45
    s_add_u32 s49, s49, s47
    s_and_b32 s52, s48, 0xffff
    s_lshr_b32 s53, s48, 16
    s_add_u32 s53, s53, s52
    s_and_b32 s54, s49, 0xffff
    s_add_u32 s54, s54, s53
    s_cmp_ge_u32 s37, 4
    s_cbranch_scc1 part_p1b
    s_lshl_b32 s50, s52, 16
    s_lshl_b32 s51, s54, 16
    s_or_b32 s51, s51, s53
    s_cmp_gt_u32 s37, 0
    s_cselect_b32 s56, s40, 0
    s_cselect_b32 s57, s41, 0
    s_add_u32 s50, s50, s56
    s_add_u32 s51, s51, s57
    s_cmp_gt_u32 s37, 1
    s_cselect_b32 s56, s42, 0
    s_cselect_b32 s57, s43, 0
    s_add_u32 s50, s50, s56
    s_add_u32 s51, s51, s57
    s_cmp_gt_u32 s37, 2
    s_cselect_b32 s56, s44, 0
    s_cselect_b32 s57, s45, 0
    s_add_u32 s50, s50, s56
    s_add_u32 s51, s51, s57
    v_sub_u32 v122, v122, v120
    v_sub_u32 v123, v123, v121
    v_add_u32 v122, s50, v122
    v_add_u32 v123, s51, v123
    v_lshlrev_b32 v8, 16, v122
    v_and_b32 v9, 0xffff0000, v122
    v_lshlrev_b32 v10, 16, v123
    v_and_b32 v11, 0xffff0000, v123
    ds_write_b128 v1, v[8:11] offset:4096
    v_or_b32 v124, v8, v116
    v_or_b32 v125, v9, v117
    v_or_b32 v126, v10, v118
    v_or_b32 v127, v11, v119
    s_waitcnt lgkmcnt(0)
part_p1b:
    s_barrier
    s_lshr_b32 s55, s49, 16
    s_add_u32 s55, s55, s54
    s_lshl_b32 s62, s55, 4
    s_add_u32 s62, s62, 127
    s_and_b32 s62, s62, -128
    s_mov_b32 s82, 0
    buffer_store_dwordx4 v[16:19], v1, s[20:23], s82 offen sc1
    v_lshrrev_b32 v8, 16, v66
    ds_add_rtn_u32 v8, v8, v4 offset:4096
    v_and_b32 v66, 0xfff, v66
    v_lshrrev_b32 v9, 16, v67
    ds_add_rtn_u32 v9, v9, v4 offset:4096
    v_and_b32 v67, 0xfff, v67
    v_lshrrev_b32 v10, 16, v68
    ds_add_rtn_u32 v10, v10, v4 offset:4096
    v_and_b32 v68, 0xfff, v68
    v_lshrrev_b32 v11, 16, v69
    ds_add_rtn_u32 v11, v11, v4 offset:4096
    v_and_b32 v69, 0xfff, v69
    v_lshrrev_b32 v12, 16, v76
    ds_add_rtn_u32 v12, v12, v4 offset:4096
    v_and_b32 v76, 0xfff, v76
    v_lshrrev_b32 v13, 16, v77
    ds_add_rtn_u32 v13, v13, v4 offset:4096
    v_and_b32 v77, 0xfff, v77
    v_lshrrev_b32 v14, 16, v78
    ds_add_rtn_u32 v14, v14, v4 offset:4096
    v_and_b32 v78, 0xfff, v78
    v_lshrrev_b32 v15, 16, v79
    ds_add_rtn_u32 v15, v15, v4 offset:4096
    v_and_b32 v79, 0xfff, v79
    s_waitcnt lgkmcnt(4)
    v_mul_hi_u32 v117, v8, s77
    v_lshrrev_b32 v116, 14, v8
    v_and_b32 v8, 0xffff, v8
    v_and_b32 v117, -4, v117
    v_mul_hi_u32_u24 v8, 196608, v8
    ds_write_b32 v117, v70 offset:38368
    v_and_b32 v116, -4, v116
    v_mul_u32_u24 v8, 10, v8
    v_lshlrev_b32 v8, v8, v66
    ds_add_u32 v116, v8 offset:8320
    v_mul_hi_u32 v119, v9, s77
    v_lshrrev_b32 v118, 14, v9
    v_and_b32 v9, 0xffff, v9
    v_and_b32 v119, -4, v119
    v_mul_hi_u32_u24 v9, 196608, v9
    ds_write_b32 v119, v71 offset:38368
    v_and_b32 v118, -4, v118
    v_mul_u32_u24 v9, 10, v9
    v_lshlrev_b32 v9, v9, v67
    ds_add_u32 v118, v9 offset:8320
    v_mul_hi_u32 v117, v10, s77
    v_lshrrev_b32 v116, 14, v10
    v_and_b32 v10, 0xffff, v10
    v_and_b32 v117, -4, v117
    v_mul_hi_u32_u24 v10, 196608, v10
    ds_write_b32 v117, v72 offset:38368
    v_and_b32 v116, -4, v116
    v_mul_u32_u24 v10, 10, v10
    v_lshlrev_b32 v10, v10, v68
    ds_add_u32 v116, v10 offset:8320
    v_mul_hi_u32 v119, v11, s77
    v_lshrrev_b32 v118, 14, v11
    v_and_b32 v11, 0xffff, v11
    v_and_b32 v119, -4, v119
    v_mul_hi_u32_u24 v11, 196608, v11
    ds_write_b32 v119, v73 offset:38368
    v_and_b32 v118, -4, v118
    v_mul_u32_u24 v11, 10, v11
    v_lshlrev_b32 v11, v11, v69
    ds_add_u32 v118, v11 offset:8320
    buffer_store_dwordx4 v[124:127], v1, s[24:27], 0 offen sc1
    s_nop 1
    s_mov_b32 s82, 16384
    buffer_store_dwordx4 v[20:23], v1, s[20:23], s82 offen sc1
    s_mov_b32 s82, 32768
    buffer_store_dwordx4 v[26:29], v1, s[20:23], s82 offen sc1
    v_lshrrev_b32 v8, 16, v86
    ds_add_rtn_u32 v8, v8, v4 offset:4096
    v_and_b32 v86, 0xfff, v86
    v_lshrrev_b32 v9, 16, v87
    ds_add_rtn_u32 v9, v9, v4 offset:4096
    v_and_b32 v87, 0xfff, v87
    v_lshrrev_b32 v10, 16, v88
    ds_add_rtn_u32 v10, v10, v4 offset:4096
    v_and_b32 v88, 0xfff, v88
    v_lshrrev_b32 v11, 16, v89
    ds_add_rtn_u32 v11, v11, v4 offset:4096
    v_and_b32 v89, 0xfff, v89
    s_waitcnt lgkmcnt(12)
    v_mul_hi_u32 v117, v12, s77
    v_lshrrev_b32 v116, 14, v12
    v_and_b32 v12, 0xffff, v12
    v_and_b32 v117, -4, v117
    v_mul_hi_u32_u24 v12, 196608, v12
    ds_write_b32 v117, v80 offset:38368
    v_and_b32 v116, -4, v116
    v_mul_u32_u24 v12, 10, v12
    v_lshlrev_b32 v12, v12, v76
    ds_add_u32 v116, v12 offset:8320
    v_mul_hi_u32 v119, v13, s77
    v_lshrrev_b32 v118, 14, v13
    v_and_b32 v13, 0xffff, v13
    v_and_b32 v119, -4, v119
    v_mul_hi_u32_u24 v13, 196608, v13
    ds_write_b32 v119, v81 offset:38368
    v_and_b32 v118, -4, v118
    v_mul_u32_u24 v13, 10, v13
    v_lshlrev_b32 v13, v13, v77
    ds_add_u32 v118, v13 offset:8320
    v_mul_hi_u32 v117, v14, s77
    v_lshrrev_b32 v116, 14, v14
    v_and_b32 v14, 0xffff, v14
    v_and_b32 v117, -4, v117
    v_mul_hi_u32_u24 v14, 196608, v14
    ds_write_b32 v117, v82 offset:38368
    v_and_b32 v116, -4, v116
    v_mul_u32_u24 v14, 10, v14
    v_lshlrev_b32 v14, v14, v78
    ds_add_u32 v116, v14 offset:8320
    v_mul_hi_u32 v119, v15, s77
    v_lshrrev_b32 v118, 14, v15
    v_and_b32 v15, 0xffff, v15
    v_and_b32 v119, -4, v119
    v_mul_hi_u32_u24 v15, 196608, v15
    ds_write_b32 v119, v83 offset:38368
    v_and_b32 v118, -4, v118
    v_mul_u32_u24 v15, 10, v15
    v_lshlrev_b32 v15, v15, v79
    ds_add_u32 v118, v15 offset:8320
    s_mov_b32 s82, 49152
    buffer_store_dwordx4 v[30:33], v1, s[20:23], s82 offen sc1
    s_mov_b32 s82, 65536
    buffer_store_dwordx4 v[36:39], v1, s[20:23], s82 offen sc1
    v_lshrrev_b32 v12, 16, v96
    ds_add_rtn_u32 v12, v12, v4 offset:4096
    v_and_b32 v96, 0xfff, v96
    v_lshrrev_b32 v13, 16, v97
    ds_add_rtn_u32 v13, v13, v4 offset:4096
    v_and_b32 v97, 0xfff, v97
    v_lshrrev_b32 v14, 16, v98
    ds_add_rtn_u32 v14, v14, v4 offset:4096
    v_and_b32 v98, 0xfff, v98
    v_lshrrev_b32 v15, 16, v99
    ds_add_rtn_u32 v15, v15, v4 offset:4096
    v_and_b32 v99, 0xfff, v99
    s_waitcnt lgkmcnt(12)
    v_mul_hi_u32 v117, v8, s77
    v_lshrrev_b32 v116, 14, v8
    v_and_b32 v8, 0xffff, v8
    v_and_b32 v117, -4, v117
    v_mul_hi_u32_u24 v8, 196608, v8
    ds_write_b32 v117, v90 offset:38368
    v_and_b32 v116, -4, v116
    v_mul_u32_u24 v8, 10, v8
    v_lshlrev_b32 v8, v8, v86
    ds_add_u32 v116, v8 offset:8320
    v_mul_hi_u32 v119, v9, s77
    v_lshrrev_b32 v118, 14, v9
    v_and_b32 v9, 0xffff, v9
    v_and_b32 v119, -4, v119
    v_mul_hi_u32_u24 v9, 196608, v9
    ds_write_b32 v119, v91 offset:38368
    v_and_b32 v118, -4, v118
    v_mul_u32_u24 v9, 10, v9
    v_lshlrev_b32 v9, v9, v87
    ds_add_u32 v118, v9 offset:8320
    v_mul_hi_u32 v117, v10, s77
    v_lshrrev_b32 v116, 14, v10
    v_and_b32 v10, 0xffff, v10
    v_and_b32 v117, -4, v117
    v_mul_hi_u32_u24 v10, 196608, v10
    ds_write_b32 v117, v92 offset:38368
    v_and_b32 v116, -4, v116
    v_mul_u32_u24 v10, 10, v10
    v_lshlrev_b32 v10, v10, v88
    ds_add_u32 v116, v10 offset:8320
    v_mul_hi_u32 v119, v11, s77
    v_lshrrev_b32 v118, 14, v11
    v_and_b32 v11, 0xffff, v11
    v_and_b32 v119, -4, v119
    v_mul_hi_u32_u24 v11, 196608, v11
    ds_write_b32 v119, v93 offset:38368
    v_and_b32 v118, -4, v118
    v_mul_u32_u24 v11, 10, v11
    v_lshlrev_b32 v11, v11, v89
    ds_add_u32 v118, v11 offset:8320
    s_mov_b32 s82, 81920
    buffer_store_dwordx4 v[40:43], v1, s[20:23], s82 offen sc1
    s_mov_b32 s82, 98304
    buffer_store_dwordx4 v[46:49], v1, s[20:23], s82 offen sc1
    v_lshrrev_b32 v8, 16, v106
    ds_add_rtn_u32 v8, v8, v4 offset:4096
    v_and_b32 v106, 0xfff, v106
    v_lshrrev_b32 v9, 16, v107
    ds_add_rtn_u32 v9, v9, v4 offset:4096
    v_and_b32 v107, 0xfff, v107
    v_lshrrev_b32 v10, 16, v108
    ds_add_rtn_u32 v10, v10, v4 offset:4096
    v_and_b32 v108, 0xfff, v108
    v_lshrrev_b32 v11, 16, v109
    ds_add_rtn_u32 v11, v11, v4 offset:4096
    v_and_b32 v109, 0xfff, v109
    s_waitcnt lgkmcnt(12)
    v_mul_hi_u32 v117, v12, s77
    v_lshrrev_b32 v116, 14, v12
    v_and_b32 v12, 0xffff, v12
    v_and_b32 v117, -4, v117
    v_mul_hi_u32_u24 v12, 196608, v12
    ds_write_b32 v117, v100 offset:38368
    v_and_b32 v116, -4, v116
    v_mul_u32_u24 v12, 10, v12
    v_lshlrev_b32 v12, v12, v96
    ds_add_u32 v116, v12 offset:8320
    v_mul_hi_u32 v119, v13, s77
    v_lshrrev_b32 v118, 14, v13
    v_and_b32 v13, 0xffff, v13
    v_and_b32 v119, -4, v119
    v_mul_hi_u32_u24 v13, 196608, v13
    ds_write_b32 v119, v101 offset:38368
    v_and_b32 v118, -4, v118
    v_mul_u32_u24 v13, 10, v13
    v_lshlrev_b32 v13, v13, v97
    ds_add_u32 v118, v13 offset:8320
    v_mul_hi_u32 v117, v14, s77
    v_lshrrev_b32 v116, 14, v14
    v_and_b32 v14, 0xffff, v14
    v_and_b32 v117, -4, v117
    v_mul_hi_u32_u24 v14, 196608, v14
    ds_write_b32 v117, v102 offset:38368
    v_and_b32 v116, -4, v116
    v_mul_u32_u24 v14, 10, v14
    v_lshlrev_b32 v14, v14, v98
    ds_add_u32 v116, v14 offset:8320
    v_mul_hi_u32 v119, v15, s77
    v_lshrrev_b32 v118, 14, v15
    v_and_b32 v15, 0xffff, v15
    v_and_b32 v119, -4, v119
    v_mul_hi_u32_u24 v15, 196608, v15
    ds_write_b32 v119, v103 offset:38368
    v_and_b32 v118, -4, v118
    v_mul_u32_u24 v15, 10, v15
    v_lshlrev_b32 v15, v15, v99
    ds_add_u32 v118, v15 offset:8320
    s_mov_b32 s82, 114688
    buffer_store_dwordx4 v[50:53], v1, s[20:23], s82 offen sc1
    s_waitcnt lgkmcnt(8)
    v_mul_hi_u32 v117, v8, s77
    v_lshrrev_b32 v116, 14, v8
    v_and_b32 v8, 0xffff, v8
    v_and_b32 v117, -4, v117
    v_mul_hi_u32_u24 v8, 196608, v8
    ds_write_b32 v117, v110 offset:38368
    v_and_b32 v116, -4, v116
    v_mul_u32_u24 v8, 10, v8
    v_lshlrev_b32 v8, v8, v106
    ds_add_u32 v116, v8 offset:8320
    v_mul_hi_u32 v119, v9, s77
    v_lshrrev_b32 v118, 14, v9
    v_and_b32 v9, 0xffff, v9
    v_and_b32 v119, -4, v119
    v_mul_hi_u32_u24 v9, 196608, v9
    ds_write_b32 v119, v111 offset:38368
    v_and_b32 v118, -4, v118
    v_mul_u32_u24 v9, 10, v9
    v_lshlrev_b32 v9, v9, v107
    ds_add_u32 v118, v9 offset:8320
    v_mul_hi_u32 v117, v10, s77
    v_lshrrev_b32 v116, 14, v10
    v_and_b32 v10, 0xffff, v10
    v_and_b32 v117, -4, v117
    v_mul_hi_u32_u24 v10, 196608, v10
    ds_write_b32 v117, v112 offset:38368
    v_and_b32 v116, -4, v116
    v_mul_u32_u24 v10, 10, v10
    v_lshlrev_b32 v10, v10, v108
    ds_add_u32 v116, v10 offset:8320
    v_mul_hi_u32 v119, v11, s77
    v_lshrrev_b32 v118, 14, v11
    v_and_b32 v11, 0xffff, v11
    v_and_b32 v119, -4, v119
    v_mul_hi_u32_u24 v11, 196608, v11
    ds_write_b32 v119, v113 offset:38368
    v_and_b32 v118, -4, v118
    v_mul_u32_u24 v11, 10, v11
    v_lshlrev_b32 v11, v11, v109
    ds_add_u32 v118, v11 offset:8320
    s_waitcnt lgkmcnt(0)
    s_barrier
    v_add_u32 v68, 38368, v6
    ds_read2_b32 v[66:67], v68 offset0:0 offset1:1
    ds_read_b32 v68, v68 offset:8
    ds_read_b32 v69, v5 offset:8320
    v_add_u32 v72, 50656, v6
    ds_read2_b32 v[70:71], v72 offset0:0 offset1:1
    ds_read_b32 v72, v72 offset:8
    ds_read_b32 v73, v5 offset:12416
    v_add_u32 v78, 62944, v6
    ds_read2_b32 v[76:77], v78 offset0:0 offset1:1
    ds_read_b32 v78, v78 offset:8
    ds_read_b32 v79, v5 offset:16512
    v_add_u32 v82, 75232, v6
    ds_read2_b32 v[80:81], v82 offset0:0 offset1:1
    ds_read_b32 v82, v82 offset:8
    ds_read_b32 v83, v5 offset:20608
    v_add_u32 v88, 87520, v6
    ds_read2_b32 v[86:87], v88 offset0:0 offset1:1
    ds_read_b32 v88, v88 offset:8
    ds_read_b32 v89, v5 offset:24704
    v_add_u32 v92, 99808, v6
    ds_read2_b32 v[90:91], v92 offset0:0 offset1:1
    ds_read_b32 v92, v92 offset:8
    ds_read_b32 v93, v5 offset:28800
    v_add_u32 v98, 112096, v6
    ds_read2_b32 v[96:97], v98 offset0:0 offset1:1
    ds_read_b32 v98, v98 offset:8
    ds_read_b32 v99, v5 offset:32896
    v_add_u32 v102, 124384, v6
    ds_read2_b32 v[100:101], v102 offset0:0 offset1:1
    ds_read_b32 v102, v102 offset:8
    ds_read_b32 v103, v5 offset:36992
    s_waitcnt lgkmcnt(15)
    s_mov_b32 s82, 0
    buffer_store_dwordx4 v[66:69], v1, s[60:63], s82 offen sc1
    s_waitcnt lgkmcnt(15)
    s_mov_b32 s82, 16384
    buffer_store_dwordx4 v[70:73], v1, s[60:63], s82 offen sc1
    s_waitcnt lgkmcnt(15)
    s_mov_b32 s82, 32768
    buffer_store_dwordx4 v[76:79], v1, s[60:63], s82 offen sc1
    s_waitcnt lgkmcnt(12)
    s_mov_b32 s82, 49152
    buffer_store_dwordx4 v[80:83], v1, s[60:63], s82 offen sc1
    s_waitcnt lgkmcnt(9)
    s_mov_b32 s82, 65536
    buffer_store_dwordx4 v[86:89], v1, s[60:63], s82 offen sc1
    s_waitcnt lgkmcnt(6)
    s_mov_b32 s82, 81920
    buffer_store_dwordx4 v[90:93], v1, s[60:63], s82 offen sc1
    s_waitcnt lgkmcnt(3)
    s_mov_b32 s82, 98304
    buffer_store_dwordx4 v[96:99], v1, s[60:63], s82 offen sc1
    s_waitcnt lgkmcnt(0)
    s_mov_b32 s82, 114688
    buffer_store_dwordx4 v[100:103], v1, s[60:63], s82 offen sc1
    s_endpgm
part_aux:
    s_cmp_gt_u32 s2, 250
    s_cbranch_scc1 part_done
    s_load_dwordx2 s[4:5], s[0:1], 24
    s_load_dwordx2 s[20:21], s[0:1], 40
    s_load_dwordx2 s[22:23], s[0:1], 56
    s_load_dwordx2 s[24:25], s[0:1], 80
    v_lshlrev_b32 v16, 7, v0
    v_mov_b32 v17, 0
    s_mov_b32 s6, 0
    s_waitcnt lgkmcnt(0)
    s_mov_b32 s8, s4
    s_mov_b32 s9, s5
    s_mov_b32 s10, 0x9c400
    s_mov_b32 s11, 0x20000
    global_load_dword v76, v17, s[20:21]
    global_load_dword v77, v17, s[22:23]
    global_load_dword v78, v17, s[24:25]
    s_getpc_b64 s[88:89]
pc_accum_kernel_1821:
    s_add_u32 s88, s88, accum_kernel-pc_accum_kernel_1821
    s_addc_u32 s89, s89, (accum_kernel-pc_accum_kernel_1821)>>32
    s_mov_b32 s90, code_end-accum_kernel
    s_mov_b32 s91, 0x20000
    v_lshlrev_b32 v15, 7, v0
    buffer_load_dword v15, v15, s[88:91], 0 offen
    v_cmp_gt_u32 vcc, 16, v0
    s_and_saveexec_b64 s[30:31], vcc
    s_cbranch_execz part_done
    s_load_dwordx4 s[4:7], s[0:1], 64
    s_load_dwordx2 s[28:29], s[0:1], 104
    v_lshrrev_b32 v16, 2, v0
    v_xor_b32 v16, v16, v0
    v_and_b32 v16, 3, v16
    v_lshlrev_b32 v16, 1, v16
    v_lshlrev_b32 v17, 4, v0
    s_waitcnt lgkmcnt(0)
    s_mov_b32 s8, s4
    s_mov_b32 s9, s5
    s_mov_b32 s10, 0xc0
    s_mov_b32 s11, 0x20000
    s_mov_b32 s12, s6
    s_mov_b32 s13, s7
    s_mov_b32 s14, 0x20
    s_mov_b32 s15, 0x20000
    s_add_u32 s16, s28, 0x3f00000
    s_addc_u32 s17, s29, 0
    s_mov_b32 s18, 1024
    s_mov_b32 s19, 0x20000
    buffer_load_ushort v40, v16, s[8:11], 0 offen offset:0
    buffer_load_ushort v41, v16, s[8:11], 0 offen offset:24
    buffer_load_ushort v42, v16, s[8:11], 0 offen offset:48
    buffer_load_ushort v43, v16, s[8:11], 0 offen offset:72
    buffer_load_ushort v44, v16, s[8:11], 0 offen offset:96
    buffer_load_ushort v45, v16, s[8:11], 0 offen offset:120
    buffer_load_ushort v46, v16, s[8:11], 0 offen offset:144
    buffer_load_ushort v47, v16, s[8:11], 0 offen offset:168
    buffer_load_ushort v48, v16, s[8:11], 0 offen offset:8
    buffer_load_ushort v49, v16, s[8:11], 0 offen offset:32
    buffer_load_ushort v50, v16, s[8:11], 0 offen offset:56
    buffer_load_ushort v51, v16, s[8:11], 0 offen offset:80
    buffer_load_ushort v52, v16, s[8:11], 0 offen offset:104
    buffer_load_ushort v53, v16, s[8:11], 0 offen offset:128
    buffer_load_ushort v54, v16, s[8:11], 0 offen offset:152
    buffer_load_ushort v55, v16, s[8:11], 0 offen offset:176
    buffer_load_ushort v56, v16, s[8:11], 0 offen offset:16
    buffer_load_ushort v57, v16, s[8:11], 0 offen offset:40
    buffer_load_ushort v58, v16, s[8:11], 0 offen offset:64
    buffer_load_ushort v59, v16, s[8:11], 0 offen offset:88
    buffer_load_ushort v60, v16, s[8:11], 0 offen offset:112
    buffer_load_ushort v61, v16, s[8:11], 0 offen offset:136
    buffer_load_ushort v62, v16, s[8:11], 0 offen offset:160
    buffer_load_ushort v63, v16, s[8:11], 0 offen offset:184
    buffer_load_ushort v64, v16, s[12:15], 0 offen offset:0
    buffer_load_ushort v65, v16, s[12:15], 0 offen offset:8
    buffer_load_ushort v66, v16, s[12:15], 0 offen offset:16
    buffer_load_ushort v67, v16, s[12:15], 0 offen offset:24
    s_waitcnt vmcnt(0)
    v_lshl_or_b32 v20, v41, 16, v40
    v_lshl_or_b32 v21, v43, 16, v42
    v_lshl_or_b32 v22, v45, 16, v44
    v_lshl_or_b32 v23, v47, 16, v46
    v_lshl_or_b32 v24, v49, 16, v48
    v_lshl_or_b32 v25, v51, 16, v50
    v_lshl_or_b32 v26, v53, 16, v52
    v_lshl_or_b32 v27, v55, 16, v54
    v_lshl_or_b32 v28, v57, 16, v56
    v_lshl_or_b32 v29, v59, 16, v58
    v_lshl_or_b32 v30, v61, 16, v60
    v_lshl_or_b32 v31, v63, 16, v62
    v_lshl_or_b32 v32, v65, 16, v64
    v_lshl_or_b32 v33, v67, 16, v66
    v_mov_b32 v34, 0
    v_mov_b32 v35, 0
    buffer_store_dwordx4 v[20:23], v17, s[16:19], 0 offen offset:0 sc1
    buffer_store_dwordx4 v[24:27], v17, s[16:19], 0 offen offset:256 sc1
    buffer_store_dwordx4 v[28:31], v17, s[16:19], 0 offen offset:512 sc1
    buffer_store_dwordx4 v[32:35], v17, s[16:19], 0 offen offset:768 sc1
part_done:
    s_endpgm
.globl accum_kernel
.p2align 8
.type accum_kernel,@function
accum_kernel:
    s_cmp_ge_u32 s2, 256
    s_cbranch_scc1 acc_done
    s_load_dwordx2 s[72:73], s[0:1], 104
    s_load_dwordx2 s[74:75], s[0:1], 0
    s_load_dwordx2 s[76:77], s[0:1], 24
    s_load_dwordx2 s[78:79], s[0:1], 40
    s_load_dwordx2 s[80:81], s[0:1], 56
    s_load_dwordx4 s[84:87], s[0:1], 80
    s_setprio 3
    s_and_b32 s32, s2, 7
    s_lshl_b32 s32, s32, 5
    s_lshr_b32 s41, s2, 3
    s_add_u32 s32, s32, s41
    v_lshrrev_b32 v86, 6, v0
    v_and_b32 v115, 63, v0
    v_readfirstlane_b32 s33, v86
    v_and_b32 v87, 31, v0
    v_lshl_add_u32 v87, v87, 4, v86
    s_lshl_b32 s41, s32, 4
    s_add_u32 s41, s41, 32768
    v_lshl_add_u32 v88, v87, 12, s41
    s_mov_b32 s42, 120192
    v_mul_lo_u32 v110, v87, s42
    v_lshlrev_b32 v89, 1, v0
    v_and_b32 v92, 3, v0
    v_bfe_u32 v96, v0, 2, 2
    v_lshlrev_b32 v97, 3, v96
    v_lshl_add_u32 v111, v92, 5, v97
    v_mov_b32 v112, 0xff80
    v_lshrrev_b32 v96, 2, v115
    v_mad_u32_u24 v97, v92, 3, v96
    v_and_b32 v97, 15, v97
    v_mad_u32_u24 v97, v92, 17, v97
    v_lshlrev_b32 v97, 3, v97
    s_mov_b32 s7, s33
    s_mul_i32 s41, s7, 544
    s_add_u32 s41, s41, 82432
    v_add_u32 v113, s41, v97
    v_min_u32 v96, 5, v96
    v_lshlrev_b32 v96, 8, v96
    v_lshl_add_u32 v96, v92, 2, v96
    s_lshl_b32 s41, s7, 4
    v_add_u32 v116, s41, v96
    v_mov_b32 v117, 80256
    v_mov_b32 v114, 4
    s_mul_i32 s41, s33, 1792
    s_add_u32 s36, s41, 134656
    s_mov_b32 s35, s36
    s_add_u32 s37, s36, 1280
    s_add_u32 s6, s36, 512
    v_mov_b32 v84, 0x404e7ff
    v_mov_b32 v85, 0x404e7ff
    s_mul_i32 s39, s7, 6672
    s_mov_b32 s34, 80384
    s_mov_b32 s40, 64
    s_mov_b32 s43, 0
    s_mov_b32 s42, 0
    s_mov_b32 s4, 0
    s_mov_b32 s3, 0
    v_lshlrev_b32 v94, 4, v0
    v_mov_b32 v54, 0
    v_mov_b32 v55, 0
    v_mov_b32 v56, 0
    v_mov_b32 v57, 0
    ds_write_b64 v113, v[84:85] offset:0
    ds_write_b64 v113, v[84:85] offset:8704
    ds_write_b64 v113, v[84:85] offset:17408
    ds_write_b64 v113, v[84:85] offset:26112
    ds_write_b64 v113, v[84:85] offset:34816
    ds_write_b64 v113, v[84:85] offset:43520
    ds_write_b32 v116, v117 offset:448
    v_bfrev_b32 v96, 1
    v_and_b32 v97, 60, v0
    ds_write_b32 v97, v96 offset:384
    v_cmp_gt_u32 vcc, 24, v0
    s_mov_b64 exec, vcc
    ds_write_b128 v94, v[54:57]
    s_mov_b64 exec, -1
    s_mov_b32 s22, 2080768
    s_mov_b32 s23, 0x20000
    s_waitcnt lgkmcnt(0)
    s_add_u32 s20, s72, 0x3bf8000
    s_addc_u32 s21, s73, 0
    buffer_load_dwordx4 v[80:83], v88, s[20:23], 0 offen
    s_barrier
    s_mov_b32 s28, s76
    s_mov_b32 s29, s77
    s_mov_b32 s30, 0x9c400
    s_mov_b32 s31, 0x20000
    s_mul_i32 s41, s32, 2500
    buffer_load_ushort v2, v89, s[28:31], s41 offen
    buffer_load_ushort v3, v89, s[28:31], s41 offen offset:2048
    s_add_u32 s28, s72, 0x3f00000
    s_addc_u32 s29, s73, 0
    s_mov_b32 s30, 1024
    v_and_b32 v90, 15, v0
    v_lshlrev_b32 v90, 4, v90
    buffer_load_dwordx4 v[58:61], v90, s[28:31], 0 offen offset:0
    buffer_load_dwordx4 v[62:65], v90, s[28:31], 0 offen offset:256
    buffer_load_dwordx4 v[66:69], v90, s[28:31], 0 offen offset:512
    buffer_load_dwordx2 v[70:71], v90, s[28:31], 0 offen offset:768
    s_mov_b32 s16, s72
    s_mov_b32 s17, s73
    s_mov_b32 s18, 0x394fe00
    s_mov_b32 s19, 0x20000
    s_mov_b32 s8, s74
    s_or_b32 s9, s75, 0x80000
    s_mov_b32 s10, 0x342
    s_mov_b32 s11, 0x20000
    s_mov_b32 s12, s74
    s_mov_b32 s13, s75
    s_mov_b32 s14, 0x271000
    s_mov_b32 s15, 0x20000
    s_mul_i32 s41, s32, 10000
    s_add_u32 s24, s86, s41
    s_addc_u32 s25, s87, 0
    s_mov_b32 s26, 10000
    s_mov_b32 s27, 0x20000
    ds_write_b128 v94, v[54:57] offset:2048
    ds_write_b128 v94, v[54:57] offset:18432
    v_cmp_gt_u32 vcc, 464, v0
    s_mov_b64 exec, vcc
    ds_write_b128 v94, v[54:57] offset:34816
    s_mov_b64 exec, -1
    s_waitcnt vmcnt(6)
    v_mov_b32 v126, v80
    s_call_b64 s[44:45], acc_build
    s_load_dwordx4 s[92:95], s[78:79], 0
    s_load_dwordx8 s[48:55], s[84:85], 0
    s_load_dwordx16 s[56:71], s[80:81], 0
    buffer_load_dwordx4 v[18:21], v38, s[16:19], 0 offen
    buffer_load_dwordx4 v[22:25], v39, s[16:19], 0 offen
    buffer_load_dwordx4 v[26:29], v40, s[16:19], 0 offen
    v_cmp_lt_i32 s[76:77], -1, v40
    buffer_load_dwordx4 v[30:33], v41, s[16:19], 0 offen
    v_cmp_lt_i32 s[72:73], -1, v41
    buffer_load_dwordx4 v[34:37], v42, s[16:19], 0 offen
    v_cmp_lt_i32 s[74:75], -1, v42
    s_setprio 2
    s_waitcnt lgkmcnt(0)
    s_lshl_b32 s84, s92, 16
    s_and_b32 s85, s92, 0xffff0000
    s_lshl_b32 s86, s93, 16
    s_and_b32 s87, s93, 0xffff0000
    s_lshl_b32 s88, s94, 16
    s_and_b32 s89, s94, 0xffff0000
    s_lshl_b32 s90, s95, 16
    s_and_b32 s91, s95, 0xffff0000
    v_lshlrev_b32 v94, 5, v0
    v_add_u32 v95, 0x8000, v94
    s_waitcnt vmcnt(5)
    v_lshlrev_b32 v86, 16, v2
    v_subrev_f32 v38, s84, v86
    v_subrev_f32 v39, s85, v86
    v_subrev_f32 v40, s86, v86
    v_subrev_f32 v41, s87, v86
    v_subrev_f32 v42, s88, v86
    v_subrev_f32 v43, s89, v86
    v_subrev_f32 v44, s90, v86
    v_subrev_f32 v45, s91, v86
    v_cvt_pk_bf16_f32 v38, 0, v38
    v_cvt_pk_bf16_f32 v39, 0, v39
    v_cvt_pk_bf16_f32 v40, 0, v40
    v_cvt_pk_bf16_f32 v41, 0, v41
    v_cvt_pk_bf16_f32 v42, 0, v42
    v_cvt_pk_bf16_f32 v43, 0, v43
    v_cvt_pk_bf16_f32 v44, 0, v44
    v_cvt_pk_bf16_f32 v45, 0, v45
    v_mul_f32 v38, v38, v38
    v_mul_f32 v39, v39, v39
    v_mul_f32 v40, v40, v40
    v_mul_f32 v41, v41, v41
    v_mul_f32 v42, v42, v42
    v_mul_f32 v43, v43, v43
    v_mul_f32 v44, v44, v44
    v_mul_f32 v45, v45, v45
    v_cvt_pk_bf16_f32 v38, 0, v38
    v_cvt_pk_bf16_f32 v39, 0, v39
    v_cvt_pk_bf16_f32 v40, 0, v40
    v_cvt_pk_bf16_f32 v41, 0, v41
    v_cvt_pk_bf16_f32 v42, 0, v42
    v_cvt_pk_bf16_f32 v43, 0, v43
    v_cvt_pk_bf16_f32 v44, 0, v44
    v_cvt_pk_bf16_f32 v45, 0, v45
    v_mul_f32 v38, 0xc1200000, v38
    v_mul_f32 v39, 0xc1200000, v39
    v_mul_f32 v40, 0xc1200000, v40
    v_mul_f32 v41, 0xc1200000, v41
    v_mul_f32 v42, 0xc1200000, v42
    v_mul_f32 v43, 0xc1200000, v43
    v_mul_f32 v44, 0xc1200000, v44
    v_mul_f32 v45, 0xc1200000, v45
    v_cvt_pk_bf16_f32 v38, 0, v38
    v_cvt_pk_bf16_f32 v39, 0, v39
    v_cvt_pk_bf16_f32 v40, 0, v40
    v_cvt_pk_bf16_f32 v41, 0, v41
    v_cvt_pk_bf16_f32 v42, 0, v42
    v_cvt_pk_bf16_f32 v43, 0, v43
    v_cvt_pk_bf16_f32 v44, 0, v44
    v_cvt_pk_bf16_f32 v45, 0, v45
    v_mul_f32 v38, 0x3fb8aa3b, v38
    v_mul_f32 v39, 0x3fb8aa3b, v39
    v_mul_f32 v40, 0x3fb8aa3b, v40
    v_mul_f32 v41, 0x3fb8aa3b, v41
    v_mul_f32 v42, 0x3fb8aa3b, v42
    v_mul_f32 v43, 0x3fb8aa3b, v43
    v_mul_f32 v44, 0x3fb8aa3b, v44
    v_mul_f32 v45, 0x3fb8aa3b, v45
    v_exp_f32 v38, v38
    v_exp_f32 v39, v39
    v_exp_f32 v40, v40
    v_exp_f32 v41, v41
    v_exp_f32 v42, v42
    v_exp_f32 v43, v43
    v_exp_f32 v44, v44
    v_exp_f32 v45, v45
    s_nop 0
    v_cvt_pk_bf16_f32 v54, v38, v39
    v_cvt_pk_bf16_f32 v55, v40, v41
    v_cvt_pk_bf16_f32 v56, v42, v43
    v_cvt_pk_bf16_f32 v57, v44, v45
    ds_write_b128 v94, v[54:57] offset:42240
    ds_write_b128 v94, v[54:57] offset:42256
    s_cmp_ge_u32 s33, 4
    s_cbranch_scc1 acc_rbf_done
    v_lshlrev_b32 v86, 16, v3
    v_subrev_f32 v38, s84, v86
    v_subrev_f32 v39, s85, v86
    v_subrev_f32 v40, s86, v86
    v_subrev_f32 v41, s87, v86
    v_subrev_f32 v42, s88, v86
    v_subrev_f32 v43, s89, v86
    v_subrev_f32 v44, s90, v86
    v_subrev_f32 v45, s91, v86
    v_cvt_pk_bf16_f32 v38, 0, v38
    v_cvt_pk_bf16_f32 v39, 0, v39
    v_cvt_pk_bf16_f32 v40, 0, v40
    v_cvt_pk_bf16_f32 v41, 0, v41
    v_cvt_pk_bf16_f32 v42, 0, v42
    v_cvt_pk_bf16_f32 v43, 0, v43
    v_cvt_pk_bf16_f32 v44, 0, v44
    v_cvt_pk_bf16_f32 v45, 0, v45
    v_mul_f32 v38, v38, v38
    v_mul_f32 v39, v39, v39
    v_mul_f32 v40, v40, v40
    v_mul_f32 v41, v41, v41
    v_mul_f32 v42, v42, v42
    v_mul_f32 v43, v43, v43
    v_mul_f32 v44, v44, v44
    v_mul_f32 v45, v45, v45
    v_cvt_pk_bf16_f32 v38, 0, v38
    v_cvt_pk_bf16_f32 v39, 0, v39
    v_cvt_pk_bf16_f32 v40, 0, v40
    v_cvt_pk_bf16_f32 v41, 0, v41
    v_cvt_pk_bf16_f32 v42, 0, v42
    v_cvt_pk_bf16_f32 v43, 0, v43
    v_cvt_pk_bf16_f32 v44, 0, v44
    v_cvt_pk_bf16_f32 v45, 0, v45
    v_mul_f32 v38, 0xc1200000, v38
    v_mul_f32 v39, 0xc1200000, v39
    v_mul_f32 v40, 0xc1200000, v40
    v_mul_f32 v41, 0xc1200000, v41
    v_mul_f32 v42, 0xc1200000, v42
    v_mul_f32 v43, 0xc1200000, v43
    v_mul_f32 v44, 0xc1200000, v44
    v_mul_f32 v45, 0xc1200000, v45
    v_cvt_pk_bf16_f32 v38, 0, v38
    v_cvt_pk_bf16_f32 v39, 0, v39
    v_cvt_pk_bf16_f32 v40, 0, v40
    v_cvt_pk_bf16_f32 v41, 0, v41
    v_cvt_pk_bf16_f32 v42, 0, v42
    v_cvt_pk_bf16_f32 v43, 0, v43
    v_cvt_pk_bf16_f32 v44, 0, v44
    v_cvt_pk_bf16_f32 v45, 0, v45
    v_mul_f32 v38, 0x3fb8aa3b, v38
    v_mul_f32 v39, 0x3fb8aa3b, v39
    v_mul_f32 v40, 0x3fb8aa3b, v40
    v_mul_f32 v41, 0x3fb8aa3b, v41
    v_mul_f32 v42, 0x3fb8aa3b, v42
    v_mul_f32 v43, 0x3fb8aa3b, v43
    v_mul_f32 v44, 0x3fb8aa3b, v44
    v_mul_f32 v45, 0x3fb8aa3b, v45
    v_exp_f32 v38, v38
    v_exp_f32 v39, v39
    v_exp_f32 v40, v40
    v_exp_f32 v41, v41
    v_exp_f32 v42, v42
    v_exp_f32 v43, v43
    v_exp_f32 v44, v44
    v_exp_f32 v45, v45
    s_nop 0
    v_cvt_pk_bf16_f32 v54, v38, v39
    v_cvt_pk_bf16_f32 v55, v40, v41
    v_cvt_pk_bf16_f32 v56, v42, v43
    v_cvt_pk_bf16_f32 v57, v44, v45
    v_cmp_gt_u32 vcc, 232, v0
    s_mov_b64 exec, vcc
    ds_write_b128 v95, v[54:57] offset:42240
    ds_write_b128 v95, v[54:57] offset:42256
    s_mov_b64 exec, -1
acc_rbf_done:
    s_mov_b64 exec, 1
    ds_add_u32 v115, v114 offset:0
    s_mov_b64 exec, -1
    s_waitcnt vmcnt(4)
    v_and_b32 v2, 0xffc, v21
    ds_add_rtn_u32 v2, v2, v114 offset:384
    v_lshrrev_b32 v3, 10, v21
    v_and_b32 v3, 0xffc, v3
    ds_add_rtn_u32 v3, v3, v114 offset:384
    v_lshrrev_b32 v4, 20, v21
    v_and_b32 v4, 0xffc, v4
    ds_add_rtn_u32 v4, v4, v114 offset:384
    s_waitcnt vmcnt(3)
    v_and_b32 v5, 0xffc, v25
    ds_add_rtn_u32 v5, v5, v114 offset:384
    v_lshrrev_b32 v6, 10, v25
    v_and_b32 v6, 0xffc, v6
    ds_add_rtn_u32 v6, v6, v114 offset:384
    v_lshrrev_b32 v7, 20, v25
    v_and_b32 v7, 0xffc, v7
    ds_add_rtn_u32 v7, v7, v114 offset:384
    s_waitcnt vmcnt(2)
    v_and_b32 v8, 0xffc, v29
    s_mov_b64 exec, s[76:77]
    ds_add_rtn_u32 v8, v8, v114 offset:384
    s_mov_b64 exec, -1
    v_lshrrev_b32 v9, 10, v29
    v_and_b32 v9, 0xffc, v9
    s_mov_b64 exec, s[76:77]
    ds_add_rtn_u32 v9, v9, v114 offset:384
    s_mov_b64 exec, -1
    v_lshrrev_b32 v10, 20, v29
    v_and_b32 v10, 0xffc, v10
    s_mov_b64 exec, s[76:77]
    ds_add_rtn_u32 v10, v10, v114 offset:384
    s_mov_b64 exec, -1
    s_waitcnt vmcnt(1)
    v_and_b32 v11, 0xffc, v33
    s_mov_b64 exec, s[72:73]
    ds_add_rtn_u32 v11, v11, v114 offset:384
    s_mov_b64 exec, -1
    v_lshrrev_b32 v12, 10, v33
    v_and_b32 v12, 0xffc, v12
    s_mov_b64 exec, s[72:73]
    ds_add_rtn_u32 v12, v12, v114 offset:384
    s_mov_b64 exec, -1
    v_lshrrev_b32 v13, 20, v33
    v_and_b32 v13, 0xffc, v13
    s_mov_b64 exec, s[72:73]
    ds_add_rtn_u32 v13, v13, v114 offset:384
    s_mov_b64 exec, -1
    v_and_b32 v123, 0xffc, v21
    s_waitcnt lgkmcnt(9)
    v_mad_u32_u24 v96, v123, 34, v2
    v_cmp_le_i32 vcc, s34, v2
    s_cbranch_vccnz acc_fs1o
    ds_write_b32 v96, v18
acc_fs1:
    v_lshrrev_b32 v123, 10, v21
    v_and_b32 v123, 0xffc, v123
    v_mad_u32_u24 v96, v123, 34, v3
    v_cmp_le_i32 vcc, s34, v3
    s_cbranch_vccnz acc_fs2o
    ds_write_b32 v96, v19
acc_fs2:
    v_lshrrev_b32 v123, 20, v21
    v_and_b32 v123, 0xffc, v123
    v_mad_u32_u24 v96, v123, 34, v4
    v_cmp_le_i32 vcc, s34, v4
    s_cbranch_vccnz acc_fs3o
    ds_write_b32 v96, v20
acc_fs3:
    v_and_b32 v123, 0xffc, v25
    s_waitcnt lgkmcnt(9)
    v_mad_u32_u24 v96, v123, 34, v5
    v_cmp_le_i32 vcc, s34, v5
    s_cbranch_vccnz acc_fs4o
    ds_write_b32 v96, v22
acc_fs4:
    v_lshrrev_b32 v123, 10, v25
    v_and_b32 v123, 0xffc, v123
    v_mad_u32_u24 v96, v123, 34, v6
    v_cmp_le_i32 vcc, s34, v6
    s_cbranch_vccnz acc_fs5o
    ds_write_b32 v96, v23
acc_fs5:
    v_lshrrev_b32 v123, 20, v25
    v_and_b32 v123, 0xffc, v123
    v_mad_u32_u24 v96, v123, 34, v7
    v_cmp_le_i32 vcc, s34, v7
    s_cbranch_vccnz acc_fs6o
    ds_write_b32 v96, v24
acc_fs6:
    v_and_b32 v123, 0xffc, v29
    s_waitcnt lgkmcnt(9)
    v_mad_u32_u24 v96, v123, 34, v8
    s_mov_b64 exec, s[76:77]
    v_cmp_le_i32 vcc, s34, v8
    s_cbranch_vccnz acc_fs7o
    ds_write_b32 v96, v26
    s_mov_b64 exec, -1
acc_fs7:
    v_lshrrev_b32 v123, 10, v29
    v_and_b32 v123, 0xffc, v123
    v_mad_u32_u24 v96, v123, 34, v9
    s_mov_b64 exec, s[76:77]
    v_cmp_le_i32 vcc, s34, v9
    s_cbranch_vccnz acc_fs8o
    ds_write_b32 v96, v27
    s_mov_b64 exec, -1
acc_fs8:
    v_lshrrev_b32 v123, 20, v29
    v_and_b32 v123, 0xffc, v123
    v_mad_u32_u24 v96, v123, 34, v10
    s_mov_b64 exec, s[76:77]
    v_cmp_le_i32 vcc, s34, v10
    s_cbranch_vccnz acc_fs9o
    ds_write_b32 v96, v28
    s_mov_b64 exec, -1
acc_fs9:
    v_and_b32 v123, 0xffc, v33
    s_waitcnt lgkmcnt(9)
    v_mad_u32_u24 v96, v123, 34, v11
    s_mov_b64 exec, s[72:73]
    v_cmp_le_i32 vcc, s34, v11
    s_cbranch_vccnz acc_fs10o
    ds_write_b32 v96, v30
    s_mov_b64 exec, -1
acc_fs10:
    v_lshrrev_b32 v123, 10, v33
    v_and_b32 v123, 0xffc, v123
    v_mad_u32_u24 v96, v123, 34, v12
    s_mov_b64 exec, s[72:73]
    v_cmp_le_i32 vcc, s34, v12
    s_cbranch_vccnz acc_fs11o
    ds_write_b32 v96, v31
    s_mov_b64 exec, -1
acc_fs11:
    v_lshrrev_b32 v123, 20, v33
    v_and_b32 v123, 0xffc, v123
    v_mad_u32_u24 v96, v123, 34, v13
    s_mov_b64 exec, s[72:73]
    v_cmp_le_i32 vcc, s34, v13
    s_cbranch_vccnz acc_fs12o
    ds_write_b32 v96, v32
    s_mov_b64 exec, -1
acc_fs12:
    s_cmp_eq_u64 s[74:75], 0
    s_cbranch_scc1 acc_p1
    s_waitcnt vmcnt(0)
    s_call_b64 s[44:45], acc_fill4
acc_p1:
    s_mov_b64 exec, 1
    ds_add_u32 v115, v114 offset:128
    s_mov_b64 exec, -1
    s_setprio 0
    ds_read_b32 v118, v111 offset:128
    s_waitcnt lgkmcnt(0)
    v_readfirstlane_b32 s41, v118
    s_cmp_ge_u32 s41, s40
    s_cselect_b32 s5, 1, 0
    s_cbranch_scc1 acc_late
    v_mov_b32 v126, v81
    s_call_b64 s[44:45], acc_build
    buffer_load_dwordx4 v[18:21], v38, s[16:19], 0 offen
    buffer_load_dwordx4 v[22:25], v39, s[16:19], 0 offen
    buffer_load_dwordx4 v[26:29], v40, s[16:19], 0 offen
    buffer_load_dwordx4 v[30:33], v41, s[16:19], 0 offen
    v_cmp_lt_i32 s[72:73], -1, v41
    buffer_load_dwordx4 v[34:37], v42, s[16:19], 0 offen
    v_cmp_lt_i32 s[74:75], -1, v42
    v_mov_b32 v118, 0
    s_nop 0
    v_readfirstlane_b32 s41, v118
    s_cmp_ge_u32 s41, s40
    s_cbranch_scc0 acc_ck13a
acc_ck13b:
acc_late:
    s_setprio 3
    ds_wrxchg_rtn_b64 v[6:7], v113, v[84:85] offset:0
    ds_wrxchg_rtn_b64 v[8:9], v113, v[84:85] offset:8704
    ds_wrxchg_rtn_b64 v[10:11], v113, v[84:85] offset:17408
    ds_wrxchg_rtn_b64 v[12:13], v113, v[84:85] offset:26112
    ds_wrxchg_rtn_b64 v[14:15], v113, v[84:85] offset:34816
    ds_wrxchg_rtn_b64 v[16:17], v113, v[84:85] offset:43520
    ds_write_b32 v116, v117 offset:448
    s_mov_b64 exec, 1
    ds_add_u32 v115, v114 offset:256
    s_mov_b64 exec, -1
    s_add_u32 s4, s4, 1536
    s_waitcnt lgkmcnt(2)
    v_and_b32 v95, 0x3ff, v6
    buffer_load_dwordx2 v[72:73], v95, s[8:11], s39 idxen
    v_and_b32 v95, 0x3ff, v7
    buffer_load_dwordx2 v[74:75], v95, s[8:11], s39 idxen
    s_add_u32 s39, s39, 106752
    v_and_b32 v95, 0x3ff, v8
    buffer_load_dwordx2 v[76:77], v95, s[8:11], s39 idxen
    v_and_b32 v95, 0x3ff, v9
    buffer_load_dwordx2 v[78:79], v95, s[8:11], s39 idxen
    s_add_u32 s39, s39, 106752
    s_cmp_eq_u32 s5, 0
    s_cbranch_scc1 acc_early
    v_mov_b32 v126, v81
    s_call_b64 s[44:45], acc_build
    buffer_load_dwordx4 v[18:21], v38, s[16:19], 0 offen
    buffer_load_dwordx4 v[22:25], v39, s[16:19], 0 offen
    buffer_load_dwordx4 v[26:29], v40, s[16:19], 0 offen
    buffer_load_dwordx4 v[30:33], v41, s[16:19], 0 offen
    v_cmp_lt_i32 s[72:73], -1, v41
    buffer_load_dwordx4 v[34:37], v42, s[16:19], 0 offen
    v_cmp_lt_i32 s[74:75], -1, v42
acc_early:
    v_mov_b32 v126, v82
    s_call_b64 s[44:45], acc_build
    v_mov_b32 v98, v38
    v_mov_b32 v99, v39
    v_mov_b32 v100, v40
    v_mov_b32 v101, v41
    v_mov_b32 v102, v42
    v_mov_b32 v126, v83
    s_call_b64 s[44:45], acc_build
    v_mov_b32 v103, v38
    v_mov_b32 v104, v39
    v_mov_b32 v105, v40
    v_mov_b32 v106, v41
    v_mov_b32 v107, v42
    s_cmp_eq_u32 s43, 0
    s_cbranch_scc1 acc_p0
    s_mov_b32 s42, 1
    v_mov_b32 v126, v80
    s_call_b64 s[44:45], acc_build
    s_mov_b32 s42, 1537
    v_mov_b32 v126, v81
    s_call_b64 s[44:45], acc_build
    s_mov_b32 s42, 3073
    v_mov_b32 v126, v82
    s_call_b64 s[44:45], acc_build
    s_mov_b32 s42, 4609
    v_mov_b32 v126, v83
    s_call_b64 s[44:45], acc_build
acc_p0:
    ds_read_b32 v118, v111 offset:256
    s_waitcnt lgkmcnt(0)
    s_setprio 2
    s_waitcnt vmcnt(4)
    v_lshrrev_b32 v119, 3, v6
    v_bitop3_b32 v121, v119, v112, v111 bitop3:0xea
    v_and_b32 v94, -9, v121
    ds_read_b128 v[54:57], v94 offset:42240
    v_readfirstlane_b32 s41, v118
    s_cmp_ge_u32 s41, s40
    s_cbranch_scc0 acc_ck14a
acc_ck14b:
    v_and_b32 v123, 0xffc, v21
    ds_add_rtn_u32 v125, v123, v114 offset:384
    v_lshrrev_b32 v124, 10, v21
    v_and_b32 v124, 0xffc, v124
    ds_add_rtn_u32 v126, v124, v114 offset:384
    s_waitcnt lgkmcnt(0)
    v_mad_u32_u24 v96, v123, 34, v125
    v_cmp_le_i32 vcc, s34, v125
    s_cbranch_vccnz acc_fs15o
    ds_write_b32 v96, v18
acc_fs15:
    v_mad_u32_u24 v96, v124, 34, v126
    v_cmp_le_i32 vcc, s34, v126
    s_cbranch_vccnz acc_fs16o
    ds_write_b32 v96, v19
acc_fs16:
    s_setprio 1
    s_waitcnt vmcnt(3)
    v_mfma_f32_4x4x4_16b_bf16 v[38:41], v[58:59], v[54:55], 0
    v_mfma_f32_4x4x4_16b_bf16 v[42:45], v[62:63], v[54:55], 0
    v_mfma_f32_4x4x4_16b_bf16 v[46:49], v[66:67], v[54:55], 0
    v_mfma_f32_4x4x4_16b_bf16 v[50:53], v[70:71], v[72:73], 0
    v_mfma_f32_4x4x4_16b_bf16 v[38:41], v[60:61], v[56:57], v[38:41]
    v_mfma_f32_4x4x4_16b_bf16 v[42:45], v[64:65], v[56:57], v[42:45]
    v_mfma_f32_4x4x4_16b_bf16 v[46:49], v[68:69], v[56:57], v[46:49]
    v_lshrrev_b32 v120, 3, v7
    v_bitop3_b32 v122, v120, v112, v111 bitop3:0xea
    v_and_b32 v94, -9, v122
    ds_read_b128 v[54:57], v94 offset:42240
    v_lshrrev_b32 v123, 20, v21
    v_and_b32 v123, 0xffc, v123
    ds_add_rtn_u32 v125, v123, v114 offset:384
    v_and_b32 v124, 0xffc, v25
    ds_add_rtn_u32 v126, v124, v114 offset:384
    v_cmpx_ne_u32 vcc, v6, v84
    v_and_b32 v86, 0x1fff0000, v119
    v_mul_f32 v86, 0x7622f983, v86
    v_fract_f32 v86, v86
    v_cos_f32 v86, v86
    v_xor_b32 v90, 8, v121
    v_xor_b32 v91, 16, v121
    v_xor_b32 v92, 24, v121
    v_add_f32 v88, v86, v86
    v_fma_f32 v87, v88, v86, -1.0
    v_fma_f32 v88, v88, v87, -v86
    v_pk_mul_f32 v[38:39], v[38:39], v[86:87] op_sel:[0,0] op_sel_hi:[1,0]
    v_pk_mul_f32 v[40:41], v[40:41], v[86:87] op_sel:[0,0] op_sel_hi:[1,0]
    v_pk_fma_f32 v[38:39], v[42:43], v[86:87], v[38:39] op_sel:[0,1,0] op_sel_hi:[1,1,1]
    v_pk_fma_f32 v[40:41], v[44:45], v[86:87], v[40:41] op_sel:[0,1,0] op_sel_hi:[1,1,1]
    v_pk_fma_f32 v[38:39], v[46:47], v[88:89], v[38:39] op_sel:[0,0,0] op_sel_hi:[1,0,1]
    v_pk_fma_f32 v[40:41], v[48:49], v[88:89], v[40:41] op_sel:[0,0,0] op_sel_hi:[1,0,1]
    v_pk_mul_f32 v[38:39], v[38:39], v[50:51]
    v_pk_mul_f32 v[40:41], v[40:41], v[52:53]
    v_cvt_f64_f32 v[46:47], v38
    ds_add_f64 v121, v[46:47] offset:2048
    v_cvt_f64_f32 v[48:49], v39
    ds_add_f64 v90, v[48:49] offset:2048
    v_cvt_f64_f32 v[50:51], v40
    ds_add_f64 v91, v[50:51] offset:2048
    v_cvt_f64_f32 v[52:53], v41
    ds_add_f64 v92, v[52:53] offset:2048
    s_mov_b64 exec, -1
    s_waitcnt lgkmcnt(4)
    v_mad_u32_u24 v96, v123, 34, v125
    v_cmp_le_i32 vcc, s34, v125
    s_cbranch_vccnz acc_fs17o
    ds_write_b32 v96, v20
acc_fs17:
    v_mad_u32_u24 v96, v124, 34, v126
    v_cmp_le_i32 vcc, s34, v126
    s_cbranch_vccnz acc_fs18o
    ds_write_b32 v96, v22
acc_fs18:
    s_waitcnt vmcnt(2)
    v_mfma_f32_4x4x4_16b_bf16 v[38:41], v[58:59], v[54:55], 0
    v_mfma_f32_4x4x4_16b_bf16 v[42:45], v[62:63], v[54:55], 0
    v_mfma_f32_4x4x4_16b_bf16 v[46:49], v[66:67], v[54:55], 0
    v_mfma_f32_4x4x4_16b_bf16 v[50:53], v[70:71], v[74:75], 0
    v_mfma_f32_4x4x4_16b_bf16 v[38:41], v[60:61], v[56:57], v[38:41]
    v_mfma_f32_4x4x4_16b_bf16 v[42:45], v[64:65], v[56:57], v[42:45]
    v_mfma_f32_4x4x4_16b_bf16 v[46:49], v[68:69], v[56:57], v[46:49]
    v_lshrrev_b32 v119, 3, v8
    v_bitop3_b32 v121, v119, v112, v111 bitop3:0xea
    v_and_b32 v94, -9, v121
    ds_read_b128 v[54:57], v94 offset:42240
    v_lshrrev_b32 v123, 10, v25
    v_and_b32 v123, 0xffc, v123
    ds_add_rtn_u32 v125, v123, v114 offset:384
    v_lshrrev_b32 v124, 20, v25
    v_and_b32 v124, 0xffc, v124
    ds_add_rtn_u32 v126, v124, v114 offset:384
    v_cmpx_ne_u32 vcc, v7, v84
    v_and_b32 v86, 0x1fff0000, v120
    v_mul_f32 v86, 0x7622f983, v86
    v_fract_f32 v86, v86
    v_cos_f32 v86, v86
    v_xor_b32 v90, 8, v122
    v_xor_b32 v91, 16, v122
    v_xor_b32 v92, 24, v122
    v_add_f32 v88, v86, v86
    v_fma_f32 v87, v88, v86, -1.0
    v_fma_f32 v88, v88, v87, -v86
    v_pk_mul_f32 v[38:39], v[38:39], v[86:87] op_sel:[0,0] op_sel_hi:[1,0]
    v_pk_mul_f32 v[40:41], v[40:41], v[86:87] op_sel:[0,0] op_sel_hi:[1,0]
    v_pk_fma_f32 v[38:39], v[42:43], v[86:87], v[38:39] op_sel:[0,1,0] op_sel_hi:[1,1,1]
    v_pk_fma_f32 v[40:41], v[44:45], v[86:87], v[40:41] op_sel:[0,1,0] op_sel_hi:[1,1,1]
    v_pk_fma_f32 v[38:39], v[46:47], v[88:89], v[38:39] op_sel:[0,0,0] op_sel_hi:[1,0,1]
    v_pk_fma_f32 v[40:41], v[48:49], v[88:89], v[40:41] op_sel:[0,0,0] op_sel_hi:[1,0,1]
    v_pk_mul_f32 v[38:39], v[38:39], v[50:51]
    v_pk_mul_f32 v[40:41], v[40:41], v[52:53]
    v_cvt_f64_f32 v[46:47], v38
    ds_add_f64 v122, v[46:47] offset:2048
    v_cvt_f64_f32 v[48:49], v39
    ds_add_f64 v90, v[48:49] offset:2048
    v_cvt_f64_f32 v[50:51], v40
    ds_add_f64 v91, v[50:51] offset:2048
    v_cvt_f64_f32 v[52:53], v41
    ds_add_f64 v92, v[52:53] offset:2048
    s_mov_b64 exec, -1
    v_and_b32 v95, 0x3ff, v10
    buffer_load_dwordx2 v[72:73], v95, s[8:11], s39 idxen
    v_and_b32 v95, 0x3ff, v11
    buffer_load_dwordx2 v[74:75], v95, s[8:11], s39 idxen
    s_add_u32 s39, s39, 106752
    s_waitcnt lgkmcnt(4)
    v_mad_u32_u24 v96, v123, 34, v125
    v_cmp_le_i32 vcc, s34, v125
    s_cbranch_vccnz acc_fs19o
    ds_write_b32 v96, v23
acc_fs19:
    v_mad_u32_u24 v96, v124, 34, v126
    v_cmp_le_i32 vcc, s34, v126
    s_cbranch_vccnz acc_fs20o
    ds_write_b32 v96, v24
acc_fs20:
    s_setprio 0
    s_waitcnt vmcnt(3)
    v_mfma_f32_4x4x4_16b_bf16 v[38:41], v[58:59], v[54:55], 0
    v_mfma_f32_4x4x4_16b_bf16 v[42:45], v[62:63], v[54:55], 0
    v_mfma_f32_4x4x4_16b_bf16 v[46:49], v[66:67], v[54:55], 0
    v_mfma_f32_4x4x4_16b_bf16 v[50:53], v[70:71], v[76:77], 0
    v_mfma_f32_4x4x4_16b_bf16 v[38:41], v[60:61], v[56:57], v[38:41]
    v_mfma_f32_4x4x4_16b_bf16 v[42:45], v[64:65], v[56:57], v[42:45]
    v_mfma_f32_4x4x4_16b_bf16 v[46:49], v[68:69], v[56:57], v[46:49]
    v_lshrrev_b32 v120, 3, v9
    v_bitop3_b32 v122, v120, v112, v111 bitop3:0xea
    v_and_b32 v94, -9, v122
    ds_read_b128 v[54:57], v94 offset:42240
    v_and_b32 v123, 0xffc, v29
    ds_add_rtn_u32 v125, v123, v114 offset:384
    v_lshrrev_b32 v124, 10, v29
    v_and_b32 v124, 0xffc, v124
    ds_add_rtn_u32 v126, v124, v114 offset:384
    v_cmpx_ne_u32 vcc, v8, v84
    v_and_b32 v86, 0x1fff0000, v119
    v_mul_f32 v86, 0x7622f983, v86
    v_fract_f32 v86, v86
    v_cos_f32 v86, v86
    v_xor_b32 v90, 8, v121
    v_xor_b32 v91, 16, v121
    v_xor_b32 v92, 24, v121
    v_add_f32 v88, v86, v86
    v_fma_f32 v87, v88, v86, -1.0
    v_fma_f32 v88, v88, v87, -v86
    v_pk_mul_f32 v[38:39], v[38:39], v[86:87] op_sel:[0,0] op_sel_hi:[1,0]
    v_pk_mul_f32 v[40:41], v[40:41], v[86:87] op_sel:[0,0] op_sel_hi:[1,0]
    v_pk_fma_f32 v[38:39], v[42:43], v[86:87], v[38:39] op_sel:[0,1,0] op_sel_hi:[1,1,1]
    v_pk_fma_f32 v[40:41], v[44:45], v[86:87], v[40:41] op_sel:[0,1,0] op_sel_hi:[1,1,1]
    v_pk_fma_f32 v[38:39], v[46:47], v[88:89], v[38:39] op_sel:[0,0,0] op_sel_hi:[1,0,1]
    v_pk_fma_f32 v[40:41], v[48:49], v[88:89], v[40:41] op_sel:[0,0,0] op_sel_hi:[1,0,1]
    v_pk_mul_f32 v[38:39], v[38:39], v[50:51]
    v_pk_mul_f32 v[40:41], v[40:41], v[52:53]
    v_cvt_f64_f32 v[46:47], v38
    ds_add_f64 v121, v[46:47] offset:2048
    v_cvt_f64_f32 v[48:49], v39
    ds_add_f64 v90, v[48:49] offset:2048
    v_cvt_f64_f32 v[50:51], v40
    ds_add_f64 v91, v[50:51] offset:2048
    v_cvt_f64_f32 v[52:53], v41
    ds_add_f64 v92, v[52:53] offset:2048
    s_mov_b64 exec, -1
    s_waitcnt lgkmcnt(4)
    v_mad_u32_u24 v96, v123, 34, v125
    v_cmp_le_i32 vcc, s34, v125
    s_cbranch_vccnz acc_fs21o
    ds_write_b32 v96, v26
acc_fs21:
    v_mad_u32_u24 v96, v124, 34, v126
    v_cmp_le_i32 vcc, s34, v126
    s_cbranch_vccnz acc_fs22o
    ds_write_b32 v96, v27
acc_fs22:
    buffer_load_dwordx4 v[18:21], v98, s[16:19], 0 offen
    s_waitcnt vmcnt(3)
    v_mfma_f32_4x4x4_16b_bf16 v[38:41], v[58:59], v[54:55], 0
    v_mfma_f32_4x4x4_16b_bf16 v[42:45], v[62:63], v[54:55], 0
    v_mfma_f32_4x4x4_16b_bf16 v[46:49], v[66:67], v[54:55], 0
    v_mfma_f32_4x4x4_16b_bf16 v[50:53], v[70:71], v[78:79], 0
    v_mfma_f32_4x4x4_16b_bf16 v[38:41], v[60:61], v[56:57], v[38:41]
    v_mfma_f32_4x4x4_16b_bf16 v[42:45], v[64:65], v[56:57], v[42:45]
    v_mfma_f32_4x4x4_16b_bf16 v[46:49], v[68:69], v[56:57], v[46:49]
    v_lshrrev_b32 v119, 3, v10
    v_bitop3_b32 v121, v119, v112, v111 bitop3:0xea
    v_and_b32 v94, -9, v121
    ds_read_b128 v[54:57], v94 offset:42240
    v_lshrrev_b32 v123, 20, v29
    v_and_b32 v123, 0xffc, v123
    ds_add_rtn_u32 v125, v123, v114 offset:384
    v_and_b32 v124, 0xffc, v33
    s_mov_b64 exec, s[72:73]
    ds_add_rtn_u32 v126, v124, v114 offset:384
    s_mov_b64 exec, -1
    v_cmpx_ne_u32 vcc, v9, v84
    v_and_b32 v86, 0x1fff0000, v120
    v_mul_f32 v86, 0x7622f983, v86
    v_fract_f32 v86, v86
    v_cos_f32 v86, v86
    v_xor_b32 v90, 8, v122
    v_xor_b32 v91, 16, v122
    v_xor_b32 v92, 24, v122
    v_add_f32 v88, v86, v86
    v_fma_f32 v87, v88, v86, -1.0
    v_fma_f32 v88, v88, v87, -v86
    v_pk_mul_f32 v[38:39], v[38:39], v[86:87] op_sel:[0,0] op_sel_hi:[1,0]
    v_pk_mul_f32 v[40:41], v[40:41], v[86:87] op_sel:[0,0] op_sel_hi:[1,0]
    v_pk_fma_f32 v[38:39], v[42:43], v[86:87], v[38:39] op_sel:[0,1,0] op_sel_hi:[1,1,1]
    v_pk_fma_f32 v[40:41], v[44:45], v[86:87], v[40:41] op_sel:[0,1,0] op_sel_hi:[1,1,1]
    v_pk_fma_f32 v[38:39], v[46:47], v[88:89], v[38:39] op_sel:[0,0,0] op_sel_hi:[1,0,1]
    v_pk_fma_f32 v[40:41], v[48:49], v[88:89], v[40:41] op_sel:[0,0,0] op_sel_hi:[1,0,1]
    v_pk_mul_f32 v[38:39], v[38:39], v[50:51]
    v_pk_mul_f32 v[40:41], v[40:41], v[52:53]
    v_cvt_f64_f32 v[46:47], v38
    ds_add_f64 v122, v[46:47] offset:2048
    v_cvt_f64_f32 v[48:49], v39
    ds_add_f64 v90, v[48:49] offset:2048
    v_cvt_f64_f32 v[50:51], v40
    ds_add_f64 v91, v[50:51] offset:2048
    v_cvt_f64_f32 v[52:53], v41
    ds_add_f64 v92, v[52:53] offset:2048
    s_mov_b64 exec, -1
    v_and_b32 v95, 0x3ff, v12
    buffer_load_dwordx2 v[76:77], v95, s[8:11], s39 idxen
    v_and_b32 v95, 0x3ff, v13
    buffer_load_dwordx2 v[78:79], v95, s[8:11], s39 idxen
    s_add_u32 s39, s39, 106752
    s_waitcnt lgkmcnt(4)
    v_mad_u32_u24 v96, v123, 34, v125
    v_cmp_le_i32 vcc, s34, v125
    s_cbranch_vccnz acc_fs23o
    ds_write_b32 v96, v28
acc_fs23:
    v_mad_u32_u24 v96, v124, 34, v126
    s_mov_b64 exec, s[72:73]
    v_cmp_le_i32 vcc, s34, v126
    s_cbranch_vccnz acc_fs24o
    ds_write_b32 v96, v30
    s_mov_b64 exec, -1
acc_fs24:
    s_waitcnt vmcnt(4)
    v_mfma_f32_4x4x4_16b_bf16 v[38:41], v[58:59], v[54:55], 0
    v_mfma_f32_4x4x4_16b_bf16 v[42:45], v[62:63], v[54:55], 0
    v_mfma_f32_4x4x4_16b_bf16 v[46:49], v[66:67], v[54:55], 0
    v_mfma_f32_4x4x4_16b_bf16 v[50:53], v[70:71], v[72:73], 0
    v_mfma_f32_4x4x4_16b_bf16 v[38:41], v[60:61], v[56:57], v[38:41]
    v_mfma_f32_4x4x4_16b_bf16 v[42:45], v[64:65], v[56:57], v[42:45]
    v_mfma_f32_4x4x4_16b_bf16 v[46:49], v[68:69], v[56:57], v[46:49]
    v_lshrrev_b32 v120, 3, v11
    v_bitop3_b32 v122, v120, v112, v111 bitop3:0xea
    v_and_b32 v94, -9, v122
    ds_read_b128 v[54:57], v94 offset:42240
    v_lshrrev_b32 v123, 10, v33
    v_and_b32 v123, 0xffc, v123
    s_mov_b64 exec, s[72:73]
    ds_add_rtn_u32 v125, v123, v114 offset:384
    s_mov_b64 exec, -1
    v_lshrrev_b32 v124, 20, v33
    v_and_b32 v124, 0xffc, v124
    s_mov_b64 exec, s[72:73]
    ds_add_rtn_u32 v126, v124, v114 offset:384
    s_mov_b64 exec, -1
    v_cmpx_ne_u32 vcc, v10, v84
    v_and_b32 v86, 0x1fff0000, v119
    v_mul_f32 v86, 0x7622f983, v86
    v_fract_f32 v86, v86
    v_cos_f32 v86, v86
    v_xor_b32 v90, 8, v121
    v_xor_b32 v91, 16, v121
    v_xor_b32 v92, 24, v121
    v_add_f32 v88, v86, v86
    v_fma_f32 v87, v88, v86, -1.0
    v_fma_f32 v88, v88, v87, -v86
    v_pk_mul_f32 v[38:39], v[38:39], v[86:87] op_sel:[0,0] op_sel_hi:[1,0]
    v_pk_mul_f32 v[40:41], v[40:41], v[86:87] op_sel:[0,0] op_sel_hi:[1,0]
    v_pk_fma_f32 v[38:39], v[42:43], v[86:87], v[38:39] op_sel:[0,1,0] op_sel_hi:[1,1,1]
    v_pk_fma_f32 v[40:41], v[44:45], v[86:87], v[40:41] op_sel:[0,1,0] op_sel_hi:[1,1,1]
    v_pk_fma_f32 v[38:39], v[46:47], v[88:89], v[38:39] op_sel:[0,0,0] op_sel_hi:[1,0,1]
    v_pk_fma_f32 v[40:41], v[48:49], v[88:89], v[40:41] op_sel:[0,0,0] op_sel_hi:[1,0,1]
    v_pk_mul_f32 v[38:39], v[38:39], v[50:51]
    v_pk_mul_f32 v[40:41], v[40:41], v[52:53]
    v_cvt_f64_f32 v[46:47], v38
    ds_add_f64 v121, v[46:47] offset:2048
    v_cvt_f64_f32 v[48:49], v39
    ds_add_f64 v90, v[48:49] offset:2048
    v_cvt_f64_f32 v[50:51], v40
    ds_add_f64 v91, v[50:51] offset:2048
    v_cvt_f64_f32 v[52:53], v41
    ds_add_f64 v92, v[52:53] offset:2048
    s_mov_b64 exec, -1
    s_waitcnt lgkmcnt(4)
    v_mad_u32_u24 v96, v123, 34, v125
    s_mov_b64 exec, s[72:73]
    v_cmp_le_i32 vcc, s34, v125
    s_cbranch_vccnz acc_fs25o
    ds_write_b32 v96, v31
    s_mov_b64 exec, -1
acc_fs25:
    v_mad_u32_u24 v96, v124, 34, v126
    s_mov_b64 exec, s[72:73]
    v_cmp_le_i32 vcc, s34, v126
    s_cbranch_vccnz acc_fs26o
    ds_write_b32 v96, v32
    s_mov_b64 exec, -1
acc_fs26:
    s_cmp_eq_u64 s[74:75], 0
    s_cbranch_scc1 acc_no4first
    s_call_b64 s[44:45], acc_fill4
    v_lshrrev_b32 v120, 3, v11
    v_bitop3_b32 v122, v120, v112, v111 bitop3:0xea
    v_and_b32 v94, -9, v122
    ds_read_b128 v[54:57], v94 offset:42240
    s_waitcnt lgkmcnt(0)
acc_no4first:
    s_lshl_b32 s41, s33, 2
    v_mov_b32 v96, s41
    v_mov_b32 v97, s35
    ds_write_b32 v96, v97 offset:64
    s_mov_b64 exec, 1
    ds_add_u32 v115, v114 offset:128
    s_mov_b64 exec, -1
    buffer_load_dwordx4 v[22:25], v99, s[16:19], 0 offen
    s_setprio 3
    s_waitcnt vmcnt(4)
    v_mfma_f32_4x4x4_16b_bf16 v[38:41], v[58:59], v[54:55], 0
    v_mfma_f32_4x4x4_16b_bf16 v[42:45], v[62:63], v[54:55], 0
    v_mfma_f32_4x4x4_16b_bf16 v[46:49], v[66:67], v[54:55], 0
    v_mfma_f32_4x4x4_16b_bf16 v[50:53], v[70:71], v[74:75], 0
    v_mfma_f32_4x4x4_16b_bf16 v[38:41], v[60:61], v[56:57], v[38:41]
    v_mfma_f32_4x4x4_16b_bf16 v[42:45], v[64:65], v[56:57], v[42:45]
    v_mfma_f32_4x4x4_16b_bf16 v[46:49], v[68:69], v[56:57], v[46:49]
    v_lshrrev_b32 v119, 3, v12
    v_bitop3_b32 v121, v119, v112, v111 bitop3:0xea
    v_and_b32 v94, -9, v121
    ds_read_b128 v[54:57], v94 offset:42240
    v_cmpx_ne_u32 vcc, v11, v84
    v_and_b32 v86, 0x1fff0000, v120
    v_mul_f32 v86, 0x7622f983, v86
    v_fract_f32 v86, v86
    v_cos_f32 v86, v86
    v_xor_b32 v90, 8, v122
    v_xor_b32 v91, 16, v122
    v_xor_b32 v92, 24, v122
    v_add_f32 v88, v86, v86
    v_fma_f32 v87, v88, v86, -1.0
    v_fma_f32 v88, v88, v87, -v86
    v_pk_mul_f32 v[38:39], v[38:39], v[86:87] op_sel:[0,0] op_sel_hi:[1,0]
    v_pk_mul_f32 v[40:41], v[40:41], v[86:87] op_sel:[0,0] op_sel_hi:[1,0]
    v_pk_fma_f32 v[38:39], v[42:43], v[86:87], v[38:39] op_sel:[0,1,0] op_sel_hi:[1,1,1]
    v_pk_fma_f32 v[40:41], v[44:45], v[86:87], v[40:41] op_sel:[0,1,0] op_sel_hi:[1,1,1]
    v_pk_fma_f32 v[38:39], v[46:47], v[88:89], v[38:39] op_sel:[0,0,0] op_sel_hi:[1,0,1]
    v_pk_fma_f32 v[40:41], v[48:49], v[88:89], v[40:41] op_sel:[0,0,0] op_sel_hi:[1,0,1]
    v_pk_mul_f32 v[38:39], v[38:39], v[50:51]
    v_pk_mul_f32 v[40:41], v[40:41], v[52:53]
    v_cvt_f64_f32 v[46:47], v38
    ds_add_f64 v122, v[46:47] offset:2048
    v_cvt_f64_f32 v[48:49], v39
    ds_add_f64 v90, v[48:49] offset:2048
    v_cvt_f64_f32 v[50:51], v40
    ds_add_f64 v91, v[50:51] offset:2048
    v_cvt_f64_f32 v[52:53], v41
    ds_add_f64 v92, v[52:53] offset:2048
    s_mov_b64 exec, -1
    v_and_b32 v95, 0x3ff, v14
    buffer_load_dwordx2 v[72:73], v95, s[8:11], s39 idxen
    v_and_b32 v95, 0x3ff, v15
    buffer_load_dwordx2 v[74:75], v95, s[8:11], s39 idxen
    s_add_u32 s39, s39, 106752
    s_waitcnt vmcnt(4) lgkmcnt(4)
    v_mfma_f32_4x4x4_16b_bf16 v[38:41], v[58:59], v[54:55], 0
    v_mfma_f32_4x4x4_16b_bf16 v[42:45], v[62:63], v[54:55], 0
    v_mfma_f32_4x4x4_16b_bf16 v[46:49], v[66:67], v[54:55], 0
    v_mfma_f32_4x4x4_16b_bf16 v[50:53], v[70:71], v[76:77], 0
    v_mfma_f32_4x4x4_16b_bf16 v[38:41], v[60:61], v[56:57], v[38:41]
    v_mfma_f32_4x4x4_16b_bf16 v[42:45], v[64:65], v[56:57], v[42:45]
    v_mfma_f32_4x4x4_16b_bf16 v[46:49], v[68:69], v[56:57], v[46:49]
    v_lshrrev_b32 v120, 3, v13
    v_bitop3_b32 v122, v120, v112, v111 bitop3:0xea
    v_and_b32 v94, -9, v122
    ds_read_b128 v[54:57], v94 offset:42240
    v_cmpx_ne_u32 vcc, v12, v84
    v_and_b32 v86, 0x1fff0000, v119
    v_mul_f32 v86, 0x7622f983, v86
    v_fract_f32 v86, v86
    v_cos_f32 v86, v86
    v_xor_b32 v90, 8, v121
    v_xor_b32 v91, 16, v121
    v_xor_b32 v92, 24, v121
    v_add_f32 v88, v86, v86
    v_fma_f32 v87, v88, v86, -1.0
    v_fma_f32 v88, v88, v87, -v86
    v_pk_mul_f32 v[38:39], v[38:39], v[86:87] op_sel:[0,0] op_sel_hi:[1,0]
    v_pk_mul_f32 v[40:41], v[40:41], v[86:87] op_sel:[0,0] op_sel_hi:[1,0]
    v_pk_fma_f32 v[38:39], v[42:43], v[86:87], v[38:39] op_sel:[0,1,0] op_sel_hi:[1,1,1]
    v_pk_fma_f32 v[40:41], v[44:45], v[86:87], v[40:41] op_sel:[0,1,0] op_sel_hi:[1,1,1]
    v_pk_fma_f32 v[38:39], v[46:47], v[88:89], v[38:39] op_sel:[0,0,0] op_sel_hi:[1,0,1]
    v_pk_fma_f32 v[40:41], v[48:49], v[88:89], v[40:41] op_sel:[0,0,0] op_sel_hi:[1,0,1]
    v_pk_mul_f32 v[38:39], v[38:39], v[50:51]
    v_pk_mul_f32 v[40:41], v[40:41], v[52:53]
    v_cvt_f64_f32 v[46:47], v38
    ds_add_f64 v121, v[46:47] offset:2048
    v_cvt_f64_f32 v[48:49], v39
    ds_add_f64 v90, v[48:49] offset:2048
    v_cvt_f64_f32 v[50:51], v40
    ds_add_f64 v91, v[50:51] offset:2048
    v_cvt_f64_f32 v[52:53], v41
    ds_add_f64 v92, v[52:53] offset:2048
    s_mov_b64 exec, -1
    buffer_load_dwordx4 v[26:29], v100, s[16:19], 0 offen
    s_waitcnt vmcnt(4) lgkmcnt(4)
    v_mfma_f32_4x4x4_16b_bf16 v[38:41], v[58:59], v[54:55], 0
    v_mfma_f32_4x4x4_16b_bf16 v[42:45], v[62:63], v[54:55], 0
    v_mfma_f32_4x4x4_16b_bf16 v[46:49], v[66:67], v[54:55], 0
    v_mfma_f32_4x4x4_16b_bf16 v[50:53], v[70:71], v[78:79], 0
    v_mfma_f32_4x4x4_16b_bf16 v[38:41], v[60:61], v[56:57], v[38:41]
    v_mfma_f32_4x4x4_16b_bf16 v[42:45], v[64:65], v[56:57], v[42:45]
    v_mfma_f32_4x4x4_16b_bf16 v[46:49], v[68:69], v[56:57], v[46:49]
    v_lshrrev_b32 v119, 3, v14
    v_bitop3_b32 v121, v119, v112, v111 bitop3:0xea
    v_and_b32 v94, -9, v121
    ds_read_b128 v[54:57], v94 offset:42240
    ds_read_b32 v118, v111 offset:128
    v_cmpx_ne_u32 vcc, v13, v84
    v_and_b32 v86, 0x1fff0000, v120
    v_mul_f32 v86, 0x7622f983, v86
    v_fract_f32 v86, v86
    v_cos_f32 v86, v86
    v_xor_b32 v90, 8, v122
    v_xor_b32 v91, 16, v122
    v_xor_b32 v92, 24, v122
    v_add_f32 v88, v86, v86
    v_fma_f32 v87, v88, v86, -1.0
    v_fma_f32 v88, v88, v87, -v86
    v_pk_mul_f32 v[38:39], v[38:39], v[86:87] op_sel:[0,0] op_sel_hi:[1,0]
    v_pk_mul_f32 v[40:41], v[40:41], v[86:87] op_sel:[0,0] op_sel_hi:[1,0]
    v_pk_fma_f32 v[38:39], v[42:43], v[86:87], v[38:39] op_sel:[0,1,0] op_sel_hi:[1,1,1]
    v_pk_fma_f32 v[40:41], v[44:45], v[86:87], v[40:41] op_sel:[0,1,0] op_sel_hi:[1,1,1]
    v_pk_fma_f32 v[38:39], v[46:47], v[88:89], v[38:39] op_sel:[0,0,0] op_sel_hi:[1,0,1]
    v_pk_fma_f32 v[40:41], v[48:49], v[88:89], v[40:41] op_sel:[0,0,0] op_sel_hi:[1,0,1]
    v_pk_mul_f32 v[38:39], v[38:39], v[50:51]
    v_pk_mul_f32 v[40:41], v[40:41], v[52:53]
    v_cvt_f64_f32 v[46:47], v38
    ds_add_f64 v122, v[46:47] offset:2048
    v_cvt_f64_f32 v[48:49], v39
    ds_add_f64 v90, v[48:49] offset:2048
    v_cvt_f64_f32 v[50:51], v40
    ds_add_f64 v91, v[50:51] offset:2048
    v_cvt_f64_f32 v[52:53], v41
    ds_add_f64 v92, v[52:53] offset:2048
    s_mov_b64 exec, -1
    v_and_b32 v95, 0x3ff, v16
    buffer_load_dwordx2 v[76:77], v95, s[8:11], s39 idxen
    v_and_b32 v95, 0x3ff, v17
    buffer_load_dwordx2 v[78:79], v95, s[8:11], s39 idxen
    s_add_u32 s39, s39, 106752
    s_waitcnt lgkmcnt(4)
    s_add_u32 s40, s40, 64
acc_loop:
    v_readfirstlane_b32 s41, v118
    s_cmp_ge_u32 s41, s40
    s_cbranch_scc0 acc_ck27a
acc_ck27b:
    s_setprio 2
    v_mov_b32 v2, v14
    v_mov_b32 v3, v15
    v_mov_b32 v4, v16
    v_mov_b32 v5, v17
    ds_wrxchg_rtn_b64 v[6:7], v113, v[84:85] offset:0
    ds_wrxchg_rtn_b64 v[8:9], v113, v[84:85] offset:8704
    ds_wrxchg_rtn_b64 v[10:11], v113, v[84:85] offset:17408
    ds_wrxchg_rtn_b64 v[12:13], v113, v[84:85] offset:26112
    ds_wrxchg_rtn_b64 v[14:15], v113, v[84:85] offset:34816
    ds_wrxchg_rtn_b64 v[16:17], v113, v[84:85] offset:43520
    ds_write_b32 v116, v117 offset:448
    s_mov_b64 exec, 1
    ds_add_u32 v115, v114 offset:256
    s_mov_b64 exec, -1
    s_add_u32 s4, s4, 1536
    v_mov_b32 v98, v103
    v_mov_b32 v103, -256
    v_mov_b32 v99, v104
    v_mov_b32 v104, -256
    v_mov_b32 v100, v105
    v_mov_b32 v105, -256
    s_waitcnt vmcnt(4)
    v_mfma_f32_4x4x4_16b_bf16 v[38:41], v[58:59], v[54:55], 0
    v_mfma_f32_4x4x4_16b_bf16 v[42:45], v[62:63], v[54:55], 0
    v_mfma_f32_4x4x4_16b_bf16 v[46:49], v[66:67], v[54:55], 0
    v_mfma_f32_4x4x4_16b_bf16 v[50:53], v[70:71], v[72:73], 0
    v_mfma_f32_4x4x4_16b_bf16 v[38:41], v[60:61], v[56:57], v[38:41]
    v_mfma_f32_4x4x4_16b_bf16 v[42:45], v[64:65], v[56:57], v[42:45]
    v_mfma_f32_4x4x4_16b_bf16 v[46:49], v[68:69], v[56:57], v[46:49]
    v_lshrrev_b32 v120, 3, v3
    v_bitop3_b32 v122, v120, v112, v111 bitop3:0xea
    v_and_b32 v94, -9, v122
    ds_read_b128 v[54:57], v94 offset:42240
    v_cmpx_ne_u32 vcc, v2, v84
    v_and_b32 v86, 0x1fff0000, v119
    v_mul_f32 v86, 0x7622f983, v86
    v_fract_f32 v86, v86
    v_cos_f32 v86, v86
    v_xor_b32 v90, 8, v121
    v_xor_b32 v91, 16, v121
    v_xor_b32 v92, 24, v121
    v_add_f32 v88, v86, v86
    v_fma_f32 v87, v88, v86, -1.0
    v_fma_f32 v88, v88, v87, -v86
    v_pk_mul_f32 v[38:39], v[38:39], v[86:87] op_sel:[0,0] op_sel_hi:[1,0]
    v_pk_mul_f32 v[40:41], v[40:41], v[86:87] op_sel:[0,0] op_sel_hi:[1,0]
    v_pk_fma_f32 v[38:39], v[42:43], v[86:87], v[38:39] op_sel:[0,1,0] op_sel_hi:[1,1,1]
    v_pk_fma_f32 v[40:41], v[44:45], v[86:87], v[40:41] op_sel:[0,1,0] op_sel_hi:[1,1,1]
    v_pk_fma_f32 v[38:39], v[46:47], v[88:89], v[38:39] op_sel:[0,0,0] op_sel_hi:[1,0,1]
    v_pk_fma_f32 v[40:41], v[48:49], v[88:89], v[40:41] op_sel:[0,0,0] op_sel_hi:[1,0,1]
    v_pk_mul_f32 v[38:39], v[38:39], v[50:51]
    v_pk_mul_f32 v[40:41], v[40:41], v[52:53]
    v_cvt_f64_f32 v[46:47], v38
    ds_add_f64 v121, v[46:47] offset:2048
    v_cvt_f64_f32 v[48:49], v39
    ds_add_f64 v90, v[48:49] offset:2048
    v_cvt_f64_f32 v[50:51], v40
    ds_add_f64 v91, v[50:51] offset:2048
    v_cvt_f64_f32 v[52:53], v41
    ds_add_f64 v92, v[52:53] offset:2048
    s_mov_b64 exec, -1
    buffer_load_dwordx4 v[30:33], v101, s[16:19], 0 offen
    v_cmp_lt_i32 s[72:73], -1, v101
    v_mov_b32 v101, v106
    buffer_load_dwordx4 v[34:37], v102, s[16:19], 0 offen
    v_cmp_lt_i32 s[74:75], -1, v102
    v_mov_b32 v102, v107
    s_waitcnt vmcnt(5) lgkmcnt(4)
    v_mfma_f32_4x4x4_16b_bf16 v[38:41], v[58:59], v[54:55], 0
    v_mfma_f32_4x4x4_16b_bf16 v[42:45], v[62:63], v[54:55], 0
    v_mfma_f32_4x4x4_16b_bf16 v[46:49], v[66:67], v[54:55], 0
    v_mfma_f32_4x4x4_16b_bf16 v[50:53], v[70:71], v[74:75], 0
    v_mfma_f32_4x4x4_16b_bf16 v[38:41], v[60:61], v[56:57], v[38:41]
    v_mfma_f32_4x4x4_16b_bf16 v[42:45], v[64:65], v[56:57], v[42:45]
    v_mfma_f32_4x4x4_16b_bf16 v[46:49], v[68:69], v[56:57], v[46:49]
    v_lshrrev_b32 v119, 3, v4
    v_bitop3_b32 v121, v119, v112, v111 bitop3:0xea
    v_and_b32 v94, -9, v121
    ds_read_b128 v[54:57], v94 offset:42240
    v_cmpx_ne_u32 vcc, v3, v84
    v_and_b32 v86, 0x1fff0000, v120
    v_mul_f32 v86, 0x7622f983, v86
    v_fract_f32 v86, v86
    v_cos_f32 v86, v86
    v_xor_b32 v90, 8, v122
    v_xor_b32 v91, 16, v122
    v_xor_b32 v92, 24, v122
    v_add_f32 v88, v86, v86
    v_fma_f32 v87, v88, v86, -1.0
    v_fma_f32 v88, v88, v87, -v86
    v_pk_mul_f32 v[38:39], v[38:39], v[86:87] op_sel:[0,0] op_sel_hi:[1,0]
    v_pk_mul_f32 v[40:41], v[40:41], v[86:87] op_sel:[0,0] op_sel_hi:[1,0]
    v_pk_fma_f32 v[38:39], v[42:43], v[86:87], v[38:39] op_sel:[0,1,0] op_sel_hi:[1,1,1]
    v_pk_fma_f32 v[40:41], v[44:45], v[86:87], v[40:41] op_sel:[0,1,0] op_sel_hi:[1,1,1]
    v_pk_fma_f32 v[38:39], v[46:47], v[88:89], v[38:39] op_sel:[0,0,0] op_sel_hi:[1,0,1]
    v_pk_fma_f32 v[40:41], v[48:49], v[88:89], v[40:41] op_sel:[0,0,0] op_sel_hi:[1,0,1]
    v_pk_mul_f32 v[38:39], v[38:39], v[50:51]
    v_pk_mul_f32 v[40:41], v[40:41], v[52:53]
    v_cvt_f64_f32 v[46:47], v38
    ds_add_f64 v122, v[46:47] offset:2048
    v_cvt_f64_f32 v[48:49], v39
    ds_add_f64 v90, v[48:49] offset:2048
    v_cvt_f64_f32 v[50:51], v40
    ds_add_f64 v91, v[50:51] offset:2048
    v_cvt_f64_f32 v[52:53], v41
    ds_add_f64 v92, v[52:53] offset:2048
    s_mov_b64 exec, -1
    v_and_b32 v95, 0x3ff, v6
    buffer_load_dwordx2 v[72:73], v95, s[8:11], s39 idxen
    v_and_b32 v95, 0x3ff, v7
    buffer_load_dwordx2 v[74:75], v95, s[8:11], s39 idxen
    s_add_u32 s39, s39, 106752
    s_waitcnt vmcnt(5) lgkmcnt(4)
    v_mfma_f32_4x4x4_16b_bf16 v[38:41], v[58:59], v[54:55], 0
    v_mfma_f32_4x4x4_16b_bf16 v[42:45], v[62:63], v[54:55], 0
    v_mfma_f32_4x4x4_16b_bf16 v[46:49], v[66:67], v[54:55], 0
    v_mfma_f32_4x4x4_16b_bf16 v[50:53], v[70:71], v[76:77], 0
    v_mfma_f32_4x4x4_16b_bf16 v[38:41], v[60:61], v[56:57], v[38:41]
    v_mfma_f32_4x4x4_16b_bf16 v[42:45], v[64:65], v[56:57], v[42:45]
    v_mfma_f32_4x4x4_16b_bf16 v[46:49], v[68:69], v[56:57], v[46:49]
    v_lshrrev_b32 v120, 3, v5
    v_bitop3_b32 v122, v120, v112, v111 bitop3:0xea
    v_and_b32 v94, -9, v122
    ds_read_b128 v[54:57], v94 offset:42240
    ds_read_b32 v118, v111 offset:256
    v_cmpx_ne_u32 vcc, v4, v84
    v_and_b32 v86, 0x1fff0000, v119
    v_mul_f32 v86, 0x7622f983, v86
    v_fract_f32 v86, v86
    v_cos_f32 v86, v86
    v_xor_b32 v90, 8, v121
    v_xor_b32 v91, 16, v121
    v_xor_b32 v92, 24, v121
    v_add_f32 v88, v86, v86
    v_fma_f32 v87, v88, v86, -1.0
    v_fma_f32 v88, v88, v87, -v86
    v_pk_mul_f32 v[38:39], v[38:39], v[86:87] op_sel:[0,0] op_sel_hi:[1,0]
    v_pk_mul_f32 v[40:41], v[40:41], v[86:87] op_sel:[0,0] op_sel_hi:[1,0]
    v_pk_fma_f32 v[38:39], v[42:43], v[86:87], v[38:39] op_sel:[0,1,0] op_sel_hi:[1,1,1]
    v_pk_fma_f32 v[40:41], v[44:45], v[86:87], v[40:41] op_sel:[0,1,0] op_sel_hi:[1,1,1]
    v_pk_fma_f32 v[38:39], v[46:47], v[88:89], v[38:39] op_sel:[0,0,0] op_sel_hi:[1,0,1]
    v_pk_fma_f32 v[40:41], v[48:49], v[88:89], v[40:41] op_sel:[0,0,0] op_sel_hi:[1,0,1]
    v_pk_mul_f32 v[38:39], v[38:39], v[50:51]
    v_pk_mul_f32 v[40:41], v[40:41], v[52:53]
    v_cvt_f64_f32 v[46:47], v38
    ds_add_f64 v121, v[46:47] offset:2048
    v_cvt_f64_f32 v[48:49], v39
    ds_add_f64 v90, v[48:49] offset:2048
    v_cvt_f64_f32 v[50:51], v40
    ds_add_f64 v91, v[50:51] offset:2048
    v_cvt_f64_f32 v[52:53], v41
    ds_add_f64 v92, v[52:53] offset:2048
    s_mov_b64 exec, -1
    s_waitcnt lgkmcnt(4)
    s_setprio 1
    s_waitcnt vmcnt(4)
    v_mfma_f32_4x4x4_16b_bf16 v[38:41], v[58:59], v[54:55], 0
    v_mfma_f32_4x4x4_16b_bf16 v[42:45], v[62:63], v[54:55], 0
    v_mfma_f32_4x4x4_16b_bf16 v[46:49], v[66:67], v[54:55], 0
    v_mfma_f32_4x4x4_16b_bf16 v[50:53], v[70:71], v[78:79], 0
    v_mfma_f32_4x4x4_16b_bf16 v[38:41], v[60:61], v[56:57], v[38:41]
    v_mfma_f32_4x4x4_16b_bf16 v[42:45], v[64:65], v[56:57], v[42:45]
    v_mfma_f32_4x4x4_16b_bf16 v[46:49], v[68:69], v[56:57], v[46:49]
    v_lshrrev_b32 v119, 3, v6
    v_bitop3_b32 v121, v119, v112, v111 bitop3:0xea
    v_and_b32 v94, -9, v121
    ds_read_b128 v[54:57], v94 offset:42240
    v_readfirstlane_b32 s41, v118
    s_cmp_ge_u32 s41, s40
    s_cbranch_scc0 acc_ck28a
acc_ck28b:
    v_and_b32 v123, 0xffc, v21
    ds_add_rtn_u32 v125, v123, v114 offset:384
    v_lshrrev_b32 v124, 10, v21
    v_and_b32 v124, 0xffc, v124
    ds_add_rtn_u32 v126, v124, v114 offset:384
    v_cmpx_ne_u32 vcc, v5, v84
    v_and_b32 v86, 0x1fff0000, v120
    v_mul_f32 v86, 0x7622f983, v86
    v_fract_f32 v86, v86
    v_cos_f32 v86, v86
    v_xor_b32 v90, 8, v122
    v_xor_b32 v91, 16, v122
    v_xor_b32 v92, 24, v122
    v_add_f32 v88, v86, v86
    v_fma_f32 v87, v88, v86, -1.0
    v_fma_f32 v88, v88, v87, -v86
    v_pk_mul_f32 v[38:39], v[38:39], v[86:87] op_sel:[0,0] op_sel_hi:[1,0]
    v_pk_mul_f32 v[40:41], v[40:41], v[86:87] op_sel:[0,0] op_sel_hi:[1,0]
    v_pk_fma_f32 v[38:39], v[42:43], v[86:87], v[38:39] op_sel:[0,1,0] op_sel_hi:[1,1,1]
    v_pk_fma_f32 v[40:41], v[44:45], v[86:87], v[40:41] op_sel:[0,1,0] op_sel_hi:[1,1,1]
    v_pk_fma_f32 v[38:39], v[46:47], v[88:89], v[38:39] op_sel:[0,0,0] op_sel_hi:[1,0,1]
    v_pk_fma_f32 v[40:41], v[48:49], v[88:89], v[40:41] op_sel:[0,0,0] op_sel_hi:[1,0,1]
    v_pk_mul_f32 v[38:39], v[38:39], v[50:51]
    v_pk_mul_f32 v[40:41], v[40:41], v[52:53]
    v_cvt_f64_f32 v[46:47], v38
    ds_add_f64 v122, v[46:47] offset:2048
    v_cvt_f64_f32 v[48:49], v39
    ds_add_f64 v90, v[48:49] offset:2048
    v_cvt_f64_f32 v[50:51], v40
    ds_add_f64 v91, v[50:51] offset:2048
    v_cvt_f64_f32 v[52:53], v41
    ds_add_f64 v92, v[52:53] offset:2048
    s_mov_b64 exec, -1
    v_and_b32 v95, 0x3ff, v8
    buffer_load_dwordx2 v[76:77], v95, s[8:11], s39 idxen
    v_and_b32 v95, 0x3ff, v9
    buffer_load_dwordx2 v[78:79], v95, s[8:11], s39 idxen
    s_add_u32 s39, s39, 106752
    s_waitcnt lgkmcnt(4)
    v_mad_u32_u24 v96, v123, 34, v125
    v_cmp_le_i32 vcc, s34, v125
    s_cbranch_vccnz acc_fs29o
    ds_write_b32 v96, v18
acc_fs29:
    v_mad_u32_u24 v96, v124, 34, v126
    v_cmp_le_i32 vcc, s34, v126
    s_cbranch_vccnz acc_fs30o
    ds_write_b32 v96, v19
acc_fs30:
    s_waitcnt vmcnt(3)
    v_mfma_f32_4x4x4_16b_bf16 v[38:41], v[58:59], v[54:55], 0
    v_mfma_f32_4x4x4_16b_bf16 v[42:45], v[62:63], v[54:55], 0
    v_mfma_f32_4x4x4_16b_bf16 v[46:49], v[66:67], v[54:55], 0
    v_mfma_f32_4x4x4_16b_bf16 v[50:53], v[70:71], v[72:73], 0
    v_mfma_f32_4x4x4_16b_bf16 v[38:41], v[60:61], v[56:57], v[38:41]
    v_mfma_f32_4x4x4_16b_bf16 v[42:45], v[64:65], v[56:57], v[42:45]
    v_mfma_f32_4x4x4_16b_bf16 v[46:49], v[68:69], v[56:57], v[46:49]
    v_lshrrev_b32 v120, 3, v7
    v_bitop3_b32 v122, v120, v112, v111 bitop3:0xea
    v_and_b32 v94, -9, v122
    ds_read_b128 v[54:57], v94 offset:42240
    v_lshrrev_b32 v123, 20, v21
    v_and_b32 v123, 0xffc, v123
    ds_add_rtn_u32 v125, v123, v114 offset:384
    v_and_b32 v124, 0xffc, v25
    ds_add_rtn_u32 v126, v124, v114 offset:384
    v_cmpx_ne_u32 vcc, v6, v84
    v_and_b32 v86, 0x1fff0000, v119
    v_mul_f32 v86, 0x7622f983, v86
    v_fract_f32 v86, v86
    v_cos_f32 v86, v86
    v_xor_b32 v90, 8, v121
    v_xor_b32 v91, 16, v121
    v_xor_b32 v92, 24, v121
    v_add_f32 v88, v86, v86
    v_fma_f32 v87, v88, v86, -1.0
    v_fma_f32 v88, v88, v87, -v86
    v_pk_mul_f32 v[38:39], v[38:39], v[86:87] op_sel:[0,0] op_sel_hi:[1,0]
    v_pk_mul_f32 v[40:41], v[40:41], v[86:87] op_sel:[0,0] op_sel_hi:[1,0]
    v_pk_fma_f32 v[38:39], v[42:43], v[86:87], v[38:39] op_sel:[0,1,0] op_sel_hi:[1,1,1]
    v_pk_fma_f32 v[40:41], v[44:45], v[86:87], v[40:41] op_sel:[0,1,0] op_sel_hi:[1,1,1]
    v_pk_fma_f32 v[38:39], v[46:47], v[88:89], v[38:39] op_sel:[0,0,0] op_sel_hi:[1,0,1]
    v_pk_fma_f32 v[40:41], v[48:49], v[88:89], v[40:41] op_sel:[0,0,0] op_sel_hi:[1,0,1]
    v_pk_mul_f32 v[38:39], v[38:39], v[50:51]
    v_pk_mul_f32 v[40:41], v[40:41], v[52:53]
    v_cvt_f64_f32 v[46:47], v38
    ds_add_f64 v121, v[46:47] offset:2048
    v_cvt_f64_f32 v[48:49], v39
    ds_add_f64 v90, v[48:49] offset:2048
    v_cvt_f64_f32 v[50:51], v40
    ds_add_f64 v91, v[50:51] offset:2048
    v_cvt_f64_f32 v[52:53], v41
    ds_add_f64 v92, v[52:53] offset:2048
    s_mov_b64 exec, -1
    s_waitcnt lgkmcnt(4)
    v_mad_u32_u24 v96, v123, 34, v125
    v_cmp_le_i32 vcc, s34, v125
    s_cbranch_vccnz acc_fs31o
    ds_write_b32 v96, v20
acc_fs31:
    v_mad_u32_u24 v96, v124, 34, v126
    v_cmp_le_i32 vcc, s34, v126
    s_cbranch_vccnz acc_fs32o
    ds_write_b32 v96, v22
acc_fs32:
    s_waitcnt vmcnt(2)
    v_mfma_f32_4x4x4_16b_bf16 v[38:41], v[58:59], v[54:55], 0
    v_mfma_f32_4x4x4_16b_bf16 v[42:45], v[62:63], v[54:55], 0
    v_mfma_f32_4x4x4_16b_bf16 v[46:49], v[66:67], v[54:55], 0
    v_mfma_f32_4x4x4_16b_bf16 v[50:53], v[70:71], v[74:75], 0
    v_mfma_f32_4x4x4_16b_bf16 v[38:41], v[60:61], v[56:57], v[38:41]
    v_mfma_f32_4x4x4_16b_bf16 v[42:45], v[64:65], v[56:57], v[42:45]
    v_mfma_f32_4x4x4_16b_bf16 v[46:49], v[68:69], v[56:57], v[46:49]
    v_lshrrev_b32 v119, 3, v8
    v_bitop3_b32 v121, v119, v112, v111 bitop3:0xea
    v_and_b32 v94, -9, v121
    ds_read_b128 v[54:57], v94 offset:42240
    v_lshrrev_b32 v123, 10, v25
    v_and_b32 v123, 0xffc, v123
    ds_add_rtn_u32 v125, v123, v114 offset:384
    v_lshrrev_b32 v124, 20, v25
    v_and_b32 v124, 0xffc, v124
    ds_add_rtn_u32 v126, v124, v114 offset:384
    v_cmpx_ne_u32 vcc, v7, v84
    v_and_b32 v86, 0x1fff0000, v120
    v_mul_f32 v86, 0x7622f983, v86
    v_fract_f32 v86, v86
    v_cos_f32 v86, v86
    v_xor_b32 v90, 8, v122
    v_xor_b32 v91, 16, v122
    v_xor_b32 v92, 24, v122
    v_add_f32 v88, v86, v86
    v_fma_f32 v87, v88, v86, -1.0
    v_fma_f32 v88, v88, v87, -v86
    v_pk_mul_f32 v[38:39], v[38:39], v[86:87] op_sel:[0,0] op_sel_hi:[1,0]
    v_pk_mul_f32 v[40:41], v[40:41], v[86:87] op_sel:[0,0] op_sel_hi:[1,0]
    v_pk_fma_f32 v[38:39], v[42:43], v[86:87], v[38:39] op_sel:[0,1,0] op_sel_hi:[1,1,1]
    v_pk_fma_f32 v[40:41], v[44:45], v[86:87], v[40:41] op_sel:[0,1,0] op_sel_hi:[1,1,1]
    v_pk_fma_f32 v[38:39], v[46:47], v[88:89], v[38:39] op_sel:[0,0,0] op_sel_hi:[1,0,1]
    v_pk_fma_f32 v[40:41], v[48:49], v[88:89], v[40:41] op_sel:[0,0,0] op_sel_hi:[1,0,1]
    v_pk_mul_f32 v[38:39], v[38:39], v[50:51]
    v_pk_mul_f32 v[40:41], v[40:41], v[52:53]
    v_cvt_f64_f32 v[46:47], v38
    ds_add_f64 v122, v[46:47] offset:2048
    v_cvt_f64_f32 v[48:49], v39
    ds_add_f64 v90, v[48:49] offset:2048
    v_cvt_f64_f32 v[50:51], v40
    ds_add_f64 v91, v[50:51] offset:2048
    v_cvt_f64_f32 v[52:53], v41
    ds_add_f64 v92, v[52:53] offset:2048
    s_mov_b64 exec, -1
    v_and_b32 v95, 0x3ff, v10
    buffer_load_dwordx2 v[72:73], v95, s[8:11], s39 idxen
    v_and_b32 v95, 0x3ff, v11
    buffer_load_dwordx2 v[74:75], v95, s[8:11], s39 idxen
    s_add_u32 s39, s39, 106752
    s_waitcnt lgkmcnt(4)
    v_mad_u32_u24 v96, v123, 34, v125
    v_cmp_le_i32 vcc, s34, v125
    s_cbranch_vccnz acc_fs33o
    ds_write_b32 v96, v23
acc_fs33:
    v_mad_u32_u24 v96, v124, 34, v126
    v_cmp_le_i32 vcc, s34, v126
    s_cbranch_vccnz acc_fs34o
    ds_write_b32 v96, v24
acc_fs34:
    s_setprio 0
    s_waitcnt vmcnt(3)
    v_mfma_f32_4x4x4_16b_bf16 v[38:41], v[58:59], v[54:55], 0
    v_mfma_f32_4x4x4_16b_bf16 v[42:45], v[62:63], v[54:55], 0
    v_mfma_f32_4x4x4_16b_bf16 v[46:49], v[66:67], v[54:55], 0
    v_mfma_f32_4x4x4_16b_bf16 v[50:53], v[70:71], v[76:77], 0
    v_mfma_f32_4x4x4_16b_bf16 v[38:41], v[60:61], v[56:57], v[38:41]
    v_mfma_f32_4x4x4_16b_bf16 v[42:45], v[64:65], v[56:57], v[42:45]
    v_mfma_f32_4x4x4_16b_bf16 v[46:49], v[68:69], v[56:57], v[46:49]
    v_lshrrev_b32 v120, 3, v9
    v_bitop3_b32 v122, v120, v112, v111 bitop3:0xea
    v_and_b32 v94, -9, v122
    ds_read_b128 v[54:57], v94 offset:42240
    v_and_b32 v123, 0xffc, v29
    ds_add_rtn_u32 v125, v123, v114 offset:384
    v_lshrrev_b32 v124, 10, v29
    v_and_b32 v124, 0xffc, v124
    ds_add_rtn_u32 v126, v124, v114 offset:384
    v_cmpx_ne_u32 vcc, v8, v84
    v_and_b32 v86, 0x1fff0000, v119
    v_mul_f32 v86, 0x7622f983, v86
    v_fract_f32 v86, v86
    v_cos_f32 v86, v86
    v_xor_b32 v90, 8, v121
    v_xor_b32 v91, 16, v121
    v_xor_b32 v92, 24, v121
    v_add_f32 v88, v86, v86
    v_fma_f32 v87, v88, v86, -1.0
    v_fma_f32 v88, v88, v87, -v86
    v_pk_mul_f32 v[38:39], v[38:39], v[86:87] op_sel:[0,0] op_sel_hi:[1,0]
    v_pk_mul_f32 v[40:41], v[40:41], v[86:87] op_sel:[0,0] op_sel_hi:[1,0]
    v_pk_fma_f32 v[38:39], v[42:43], v[86:87], v[38:39] op_sel:[0,1,0] op_sel_hi:[1,1,1]
    v_pk_fma_f32 v[40:41], v[44:45], v[86:87], v[40:41] op_sel:[0,1,0] op_sel_hi:[1,1,1]
    v_pk_fma_f32 v[38:39], v[46:47], v[88:89], v[38:39] op_sel:[0,0,0] op_sel_hi:[1,0,1]
    v_pk_fma_f32 v[40:41], v[48:49], v[88:89], v[40:41] op_sel:[0,0,0] op_sel_hi:[1,0,1]
    v_pk_mul_f32 v[38:39], v[38:39], v[50:51]
    v_pk_mul_f32 v[40:41], v[40:41], v[52:53]
    v_cvt_f64_f32 v[46:47], v38
    ds_add_f64 v121, v[46:47] offset:2048
    v_cvt_f64_f32 v[48:49], v39
    ds_add_f64 v90, v[48:49] offset:2048
    v_cvt_f64_f32 v[50:51], v40
    ds_add_f64 v91, v[50:51] offset:2048
    v_cvt_f64_f32 v[52:53], v41
    ds_add_f64 v92, v[52:53] offset:2048
    s_mov_b64 exec, -1
    s_waitcnt lgkmcnt(4)
    v_mad_u32_u24 v96, v123, 34, v125
    v_cmp_le_i32 vcc, s34, v125
    s_cbranch_vccnz acc_fs35o
    ds_write_b32 v96, v26
acc_fs35:
    v_mad_u32_u24 v96, v124, 34, v126
    v_cmp_le_i32 vcc, s34, v126
    s_cbranch_vccnz acc_fs36o
    ds_write_b32 v96, v27
acc_fs36:
    buffer_load_dwordx4 v[18:21], v98, s[16:19], 0 offen
    s_waitcnt vmcnt(3)
    v_mfma_f32_4x4x4_16b_bf16 v[38:41], v[58:59], v[54:55], 0
    v_mfma_f32_4x4x4_16b_bf16 v[42:45], v[62:63], v[54:55], 0
    v_mfma_f32_4x4x4_16b_bf16 v[46:49], v[66:67], v[54:55], 0
    v_mfma_f32_4x4x4_16b_bf16 v[50:53], v[70:71], v[78:79], 0
    v_mfma_f32_4x4x4_16b_bf16 v[38:41], v[60:61], v[56:57], v[38:41]
    v_mfma_f32_4x4x4_16b_bf16 v[42:45], v[64:65], v[56:57], v[42:45]
    v_mfma_f32_4x4x4_16b_bf16 v[46:49], v[68:69], v[56:57], v[46:49]
    v_lshrrev_b32 v119, 3, v10
    v_bitop3_b32 v121, v119, v112, v111 bitop3:0xea
    v_and_b32 v94, -9, v121
    ds_read_b128 v[54:57], v94 offset:42240
    v_lshrrev_b32 v123, 20, v29
    v_and_b32 v123, 0xffc, v123
    ds_add_rtn_u32 v125, v123, v114 offset:384
    v_and_b32 v124, 0xffc, v33
    s_mov_b64 exec, s[72:73]
    ds_add_rtn_u32 v126, v124, v114 offset:384
    s_mov_b64 exec, -1
    v_cmpx_ne_u32 vcc, v9, v84
    v_and_b32 v86, 0x1fff0000, v120
    v_mul_f32 v86, 0x7622f983, v86
    v_fract_f32 v86, v86
    v_cos_f32 v86, v86
    v_xor_b32 v90, 8, v122
    v_xor_b32 v91, 16, v122
    v_xor_b32 v92, 24, v122
    v_add_f32 v88, v86, v86
    v_fma_f32 v87, v88, v86, -1.0
    v_fma_f32 v88, v88, v87, -v86
    v_pk_mul_f32 v[38:39], v[38:39], v[86:87] op_sel:[0,0] op_sel_hi:[1,0]
    v_pk_mul_f32 v[40:41], v[40:41], v[86:87] op_sel:[0,0] op_sel_hi:[1,0]
    v_pk_fma_f32 v[38:39], v[42:43], v[86:87], v[38:39] op_sel:[0,1,0] op_sel_hi:[1,1,1]
    v_pk_fma_f32 v[40:41], v[44:45], v[86:87], v[40:41] op_sel:[0,1,0] op_sel_hi:[1,1,1]
    v_pk_fma_f32 v[38:39], v[46:47], v[88:89], v[38:39] op_sel:[0,0,0] op_sel_hi:[1,0,1]
    v_pk_fma_f32 v[40:41], v[48:49], v[88:89], v[40:41] op_sel:[0,0,0] op_sel_hi:[1,0,1]
    v_pk_mul_f32 v[38:39], v[38:39], v[50:51]
    v_pk_mul_f32 v[40:41], v[40:41], v[52:53]
    v_cvt_f64_f32 v[46:47], v38
    ds_add_f64 v122, v[46:47] offset:2048
    v_cvt_f64_f32 v[48:49], v39
    ds_add_f64 v90, v[48:49] offset:2048
    v_cvt_f64_f32 v[50:51], v40
    ds_add_f64 v91, v[50:51] offset:2048
    v_cvt_f64_f32 v[52:53], v41
    ds_add_f64 v92, v[52:53] offset:2048
    s_mov_b64 exec, -1
    v_and_b32 v95, 0x3ff, v12
    buffer_load_dwordx2 v[76:77], v95, s[8:11], s39 idxen
    v_and_b32 v95, 0x3ff, v13
    buffer_load_dwordx2 v[78:79], v95, s[8:11], s39 idxen
    s_add_u32 s39, s39, 106752
    s_waitcnt lgkmcnt(4)
    v_mad_u32_u24 v96, v123, 34, v125
    v_cmp_le_i32 vcc, s34, v125
    s_cbranch_vccnz acc_fs37o
    ds_write_b32 v96, v28
acc_fs37:
    v_mad_u32_u24 v96, v124, 34, v126
    s_mov_b64 exec, s[72:73]
    v_cmp_le_i32 vcc, s34, v126
    s_cbranch_vccnz acc_fs38o
    ds_write_b32 v96, v30
    s_mov_b64 exec, -1
acc_fs38:
    s_waitcnt vmcnt(4)
    v_mfma_f32_4x4x4_16b_bf16 v[38:41], v[58:59], v[54:55], 0
    v_mfma_f32_4x4x4_16b_bf16 v[42:45], v[62:63], v[54:55], 0
    v_mfma_f32_4x4x4_16b_bf16 v[46:49], v[66:67], v[54:55], 0
    v_mfma_f32_4x4x4_16b_bf16 v[50:53], v[70:71], v[72:73], 0
    v_mfma_f32_4x4x4_16b_bf16 v[38:41], v[60:61], v[56:57], v[38:41]
    v_mfma_f32_4x4x4_16b_bf16 v[42:45], v[64:65], v[56:57], v[42:45]
    v_mfma_f32_4x4x4_16b_bf16 v[46:49], v[68:69], v[56:57], v[46:49]
    v_lshrrev_b32 v120, 3, v11
    v_bitop3_b32 v122, v120, v112, v111 bitop3:0xea
    v_and_b32 v94, -9, v122
    ds_read_b128 v[54:57], v94 offset:42240
    v_lshrrev_b32 v123, 10, v33
    v_and_b32 v123, 0xffc, v123
    s_mov_b64 exec, s[72:73]
    ds_add_rtn_u32 v125, v123, v114 offset:384
    s_mov_b64 exec, -1
    v_lshrrev_b32 v124, 20, v33
    v_and_b32 v124, 0xffc, v124
    s_mov_b64 exec, s[72:73]
    ds_add_rtn_u32 v126, v124, v114 offset:384
    s_mov_b64 exec, -1
    v_cmpx_ne_u32 vcc, v10, v84
    v_and_b32 v86, 0x1fff0000, v119
    v_mul_f32 v86, 0x7622f983, v86
    v_fract_f32 v86, v86
    v_cos_f32 v86, v86
    v_xor_b32 v90, 8, v121
    v_xor_b32 v91, 16, v121
    v_xor_b32 v92, 24, v121
    v_add_f32 v88, v86, v86
    v_fma_f32 v87, v88, v86, -1.0
    v_fma_f32 v88, v88, v87, -v86
    v_pk_mul_f32 v[38:39], v[38:39], v[86:87] op_sel:[0,0] op_sel_hi:[1,0]
    v_pk_mul_f32 v[40:41], v[40:41], v[86:87] op_sel:[0,0] op_sel_hi:[1,0]
    v_pk_fma_f32 v[38:39], v[42:43], v[86:87], v[38:39] op_sel:[0,1,0] op_sel_hi:[1,1,1]
    v_pk_fma_f32 v[40:41], v[44:45], v[86:87], v[40:41] op_sel:[0,1,0] op_sel_hi:[1,1,1]
    v_pk_fma_f32 v[38:39], v[46:47], v[88:89], v[38:39] op_sel:[0,0,0] op_sel_hi:[1,0,1]
    v_pk_fma_f32 v[40:41], v[48:49], v[88:89], v[40:41] op_sel:[0,0,0] op_sel_hi:[1,0,1]
    v_pk_mul_f32 v[38:39], v[38:39], v[50:51]
    v_pk_mul_f32 v[40:41], v[40:41], v[52:53]
    v_cvt_f64_f32 v[46:47], v38
    ds_add_f64 v121, v[46:47] offset:2048
    v_cvt_f64_f32 v[48:49], v39
    ds_add_f64 v90, v[48:49] offset:2048
    v_cvt_f64_f32 v[50:51], v40
    ds_add_f64 v91, v[50:51] offset:2048
    v_cvt_f64_f32 v[52:53], v41
    ds_add_f64 v92, v[52:53] offset:2048
    s_mov_b64 exec, -1
    s_waitcnt lgkmcnt(4)
    v_mad_u32_u24 v96, v123, 34, v125
    s_mov_b64 exec, s[72:73]
    v_cmp_le_i32 vcc, s34, v125
    s_cbranch_vccnz acc_fs39o
    ds_write_b32 v96, v31
    s_mov_b64 exec, -1
acc_fs39:
    v_mad_u32_u24 v96, v124, 34, v126
    s_mov_b64 exec, s[72:73]
    v_cmp_le_i32 vcc, s34, v126
    s_cbranch_vccnz acc_fs40o
    ds_write_b32 v96, v32
    s_mov_b64 exec, -1
acc_fs40:
    s_cmp_eq_u64 s[74:75], 0
    s_cbranch_scc1 acc_no4mid
    s_call_b64 s[44:45], acc_fill4
    v_lshrrev_b32 v120, 3, v11
    v_bitop3_b32 v122, v120, v112, v111 bitop3:0xea
    v_and_b32 v94, -9, v122
    ds_read_b128 v[54:57], v94 offset:42240
    s_waitcnt lgkmcnt(0)
acc_no4mid:
    s_lshl_b32 s41, s33, 2
    v_mov_b32 v96, s41
    v_mov_b32 v97, s35
    ds_write_b32 v96, v97 offset:64
    s_mov_b64 exec, 1
    ds_add_u32 v115, v114 offset:128
    s_mov_b64 exec, -1
    buffer_load_dwordx4 v[22:25], v99, s[16:19], 0 offen
    s_setprio 3
    s_waitcnt vmcnt(4)
    v_mfma_f32_4x4x4_16b_bf16 v[38:41], v[58:59], v[54:55], 0
    v_mfma_f32_4x4x4_16b_bf16 v[42:45], v[62:63], v[54:55], 0
    v_mfma_f32_4x4x4_16b_bf16 v[46:49], v[66:67], v[54:55], 0
    v_mfma_f32_4x4x4_16b_bf16 v[50:53], v[70:71], v[74:75], 0
    v_mfma_f32_4x4x4_16b_bf16 v[38:41], v[60:61], v[56:57], v[38:41]
    v_mfma_f32_4x4x4_16b_bf16 v[42:45], v[64:65], v[56:57], v[42:45]
    v_mfma_f32_4x4x4_16b_bf16 v[46:49], v[68:69], v[56:57], v[46:49]
    v_lshrrev_b32 v119, 3, v12
    v_bitop3_b32 v121, v119, v112, v111 bitop3:0xea
    v_and_b32 v94, -9, v121
    ds_read_b128 v[54:57], v94 offset:42240
    v_cmpx_ne_u32 vcc, v11, v84
    v_and_b32 v86, 0x1fff0000, v120
    v_mul_f32 v86, 0x7622f983, v86
    v_fract_f32 v86, v86
    v_cos_f32 v86, v86
    v_xor_b32 v90, 8, v122
    v_xor_b32 v91, 16, v122
    v_xor_b32 v92, 24, v122
    v_add_f32 v88, v86, v86
    v_fma_f32 v87, v88, v86, -1.0
    v_fma_f32 v88, v88, v87, -v86
    v_pk_mul_f32 v[38:39], v[38:39], v[86:87] op_sel:[0,0] op_sel_hi:[1,0]
    v_pk_mul_f32 v[40:41], v[40:41], v[86:87] op_sel:[0,0] op_sel_hi:[1,0]
    v_pk_fma_f32 v[38:39], v[42:43], v[86:87], v[38:39] op_sel:[0,1,0] op_sel_hi:[1,1,1]
    v_pk_fma_f32 v[40:41], v[44:45], v[86:87], v[40:41] op_sel:[0,1,0] op_sel_hi:[1,1,1]
    v_pk_fma_f32 v[38:39], v[46:47], v[88:89], v[38:39] op_sel:[0,0,0] op_sel_hi:[1,0,1]
    v_pk_fma_f32 v[40:41], v[48:49], v[88:89], v[40:41] op_sel:[0,0,0] op_sel_hi:[1,0,1]
    v_pk_mul_f32 v[38:39], v[38:39], v[50:51]
    v_pk_mul_f32 v[40:41], v[40:41], v[52:53]
    v_cvt_f64_f32 v[46:47], v38
    ds_add_f64 v122, v[46:47] offset:2048
    v_cvt_f64_f32 v[48:49], v39
    ds_add_f64 v90, v[48:49] offset:2048
    v_cvt_f64_f32 v[50:51], v40
    ds_add_f64 v91, v[50:51] offset:2048
    v_cvt_f64_f32 v[52:53], v41
    ds_add_f64 v92, v[52:53] offset:2048
    s_mov_b64 exec, -1
    v_and_b32 v95, 0x3ff, v14
    buffer_load_dwordx2 v[72:73], v95, s[8:11], s39 idxen
    v_and_b32 v95, 0x3ff, v15
    buffer_load_dwordx2 v[74:75], v95, s[8:11], s39 idxen
    s_add_u32 s39, s39, 106752
    s_waitcnt vmcnt(4) lgkmcnt(4)
    v_mfma_f32_4x4x4_16b_bf16 v[38:41], v[58:59], v[54:55], 0
    v_mfma_f32_4x4x4_16b_bf16 v[42:45], v[62:63], v[54:55], 0
    v_mfma_f32_4x4x4_16b_bf16 v[46:49], v[66:67], v[54:55], 0
    v_mfma_f32_4x4x4_16b_bf16 v[50:53], v[70:71], v[76:77], 0
    v_mfma_f32_4x4x4_16b_bf16 v[38:41], v[60:61], v[56:57], v[38:41]
    v_mfma_f32_4x4x4_16b_bf16 v[42:45], v[64:65], v[56:57], v[42:45]
    v_mfma_f32_4x4x4_16b_bf16 v[46:49], v[68:69], v[56:57], v[46:49]
    v_lshrrev_b32 v120, 3, v13
    v_bitop3_b32 v122, v120, v112, v111 bitop3:0xea
    v_and_b32 v94, -9, v122
    ds_read_b128 v[54:57], v94 offset:42240
    v_cmpx_ne_u32 vcc, v12, v84
    v_and_b32 v86, 0x1fff0000, v119
    v_mul_f32 v86, 0x7622f983, v86
    v_fract_f32 v86, v86
    v_cos_f32 v86, v86
    v_xor_b32 v90, 8, v121
    v_xor_b32 v91, 16, v121
    v_xor_b32 v92, 24, v121
    v_add_f32 v88, v86, v86
    v_fma_f32 v87, v88, v86, -1.0
    v_fma_f32 v88, v88, v87, -v86
    v_pk_mul_f32 v[38:39], v[38:39], v[86:87] op_sel:[0,0] op_sel_hi:[1,0]
    v_pk_mul_f32 v[40:41], v[40:41], v[86:87] op_sel:[0,0] op_sel_hi:[1,0]
    v_pk_fma_f32 v[38:39], v[42:43], v[86:87], v[38:39] op_sel:[0,1,0] op_sel_hi:[1,1,1]
    v_pk_fma_f32 v[40:41], v[44:45], v[86:87], v[40:41] op_sel:[0,1,0] op_sel_hi:[1,1,1]
    v_pk_fma_f32 v[38:39], v[46:47], v[88:89], v[38:39] op_sel:[0,0,0] op_sel_hi:[1,0,1]
    v_pk_fma_f32 v[40:41], v[48:49], v[88:89], v[40:41] op_sel:[0,0,0] op_sel_hi:[1,0,1]
    v_pk_mul_f32 v[38:39], v[38:39], v[50:51]
    v_pk_mul_f32 v[40:41], v[40:41], v[52:53]
    v_cvt_f64_f32 v[46:47], v38
    ds_add_f64 v121, v[46:47] offset:2048
    v_cvt_f64_f32 v[48:49], v39
    ds_add_f64 v90, v[48:49] offset:2048
    v_cvt_f64_f32 v[50:51], v40
    ds_add_f64 v91, v[50:51] offset:2048
    v_cvt_f64_f32 v[52:53], v41
    ds_add_f64 v92, v[52:53] offset:2048
    s_mov_b64 exec, -1
    buffer_load_dwordx4 v[26:29], v100, s[16:19], 0 offen
    s_waitcnt vmcnt(4) lgkmcnt(4)
    v_mfma_f32_4x4x4_16b_bf16 v[38:41], v[58:59], v[54:55], 0
    v_mfma_f32_4x4x4_16b_bf16 v[42:45], v[62:63], v[54:55], 0
    v_mfma_f32_4x4x4_16b_bf16 v[46:49], v[66:67], v[54:55], 0
    v_mfma_f32_4x4x4_16b_bf16 v[50:53], v[70:71], v[78:79], 0
    v_mfma_f32_4x4x4_16b_bf16 v[38:41], v[60:61], v[56:57], v[38:41]
    v_mfma_f32_4x4x4_16b_bf16 v[42:45], v[64:65], v[56:57], v[42:45]
    v_mfma_f32_4x4x4_16b_bf16 v[46:49], v[68:69], v[56:57], v[46:49]
    v_lshrrev_b32 v119, 3, v14
    v_bitop3_b32 v121, v119, v112, v111 bitop3:0xea
    v_and_b32 v94, -9, v121
    ds_read_b128 v[54:57], v94 offset:42240
    ds_read_b32 v118, v111 offset:128
    v_cmpx_ne_u32 vcc, v13, v84
    v_and_b32 v86, 0x1fff0000, v120
    v_mul_f32 v86, 0x7622f983, v86
    v_fract_f32 v86, v86
    v_cos_f32 v86, v86
    v_xor_b32 v90, 8, v122
    v_xor_b32 v91, 16, v122
    v_xor_b32 v92, 24, v122
    v_add_f32 v88, v86, v86
    v_fma_f32 v87, v88, v86, -1.0
    v_fma_f32 v88, v88, v87, -v86
    v_pk_mul_f32 v[38:39], v[38:39], v[86:87] op_sel:[0,0] op_sel_hi:[1,0]
    v_pk_mul_f32 v[40:41], v[40:41], v[86:87] op_sel:[0,0] op_sel_hi:[1,0]
    v_pk_fma_f32 v[38:39], v[42:43], v[86:87], v[38:39] op_sel:[0,1,0] op_sel_hi:[1,1,1]
    v_pk_fma_f32 v[40:41], v[44:45], v[86:87], v[40:41] op_sel:[0,1,0] op_sel_hi:[1,1,1]
    v_pk_fma_f32 v[38:39], v[46:47], v[88:89], v[38:39] op_sel:[0,0,0] op_sel_hi:[1,0,1]
    v_pk_fma_f32 v[40:41], v[48:49], v[88:89], v[40:41] op_sel:[0,0,0] op_sel_hi:[1,0,1]
    v_pk_mul_f32 v[38:39], v[38:39], v[50:51]
    v_pk_mul_f32 v[40:41], v[40:41], v[52:53]
    v_cvt_f64_f32 v[46:47], v38
    ds_add_f64 v122, v[46:47] offset:2048
    v_cvt_f64_f32 v[48:49], v39
    ds_add_f64 v90, v[48:49] offset:2048
    v_cvt_f64_f32 v[50:51], v40
    ds_add_f64 v91, v[50:51] offset:2048
    v_cvt_f64_f32 v[52:53], v41
    ds_add_f64 v92, v[52:53] offset:2048
    s_mov_b64 exec, -1
    v_and_b32 v95, 0x3ff, v16
    buffer_load_dwordx2 v[76:77], v95, s[8:11], s39 idxen
    v_and_b32 v95, 0x3ff, v17
    buffer_load_dwordx2 v[78:79], v95, s[8:11], s39 idxen
    s_add_u32 s39, s39, 106752
    s_waitcnt lgkmcnt(4)
    s_add_u32 s40, s40, 64
    s_cmp_lt_u32 s40, 256
    s_cbranch_scc1 acc_loop
    v_readfirstlane_b32 s41, v118
    s_cmp_ge_u32 s41, s40
    s_cbranch_scc0 acc_ck41a
acc_ck41b:
    s_setprio 3
    v_mov_b32 v2, v14
    v_mov_b32 v3, v15
    v_mov_b32 v4, v16
    v_mov_b32 v5, v17
    ds_read_b64 v[6:7], v113 offset:0
    ds_read_b64 v[8:9], v113 offset:8704
    ds_read_b64 v[10:11], v113 offset:17408
    ds_read_b64 v[12:13], v113 offset:26112
    ds_read_b64 v[14:15], v113 offset:34816
    ds_read_b64 v[16:17], v113 offset:43520
    s_sub_u32 s41, 15, s33
    s_mul_i32 s36, s41, 1792
    s_add_u32 s36, s36, 134656
    s_lshl_b32 s41, s41, 2
    v_mov_b32 v118, s41
    ds_read_b32 v118, v118 offset:64
    s_waitcnt vmcnt(4)
    v_mfma_f32_4x4x4_16b_bf16 v[38:41], v[58:59], v[54:55], 0
    v_mfma_f32_4x4x4_16b_bf16 v[42:45], v[62:63], v[54:55], 0
    v_mfma_f32_4x4x4_16b_bf16 v[46:49], v[66:67], v[54:55], 0
    v_mfma_f32_4x4x4_16b_bf16 v[50:53], v[70:71], v[72:73], 0
    v_mfma_f32_4x4x4_16b_bf16 v[38:41], v[60:61], v[56:57], v[38:41]
    v_mfma_f32_4x4x4_16b_bf16 v[42:45], v[64:65], v[56:57], v[42:45]
    v_mfma_f32_4x4x4_16b_bf16 v[46:49], v[68:69], v[56:57], v[46:49]
    v_lshrrev_b32 v120, 3, v3
    v_bitop3_b32 v122, v120, v112, v111 bitop3:0xea
    v_and_b32 v94, -9, v122
    ds_read_b128 v[54:57], v94 offset:42240
    v_cmpx_ne_u32 vcc, v2, v84
    v_and_b32 v86, 0x1fff0000, v119
    v_mul_f32 v86, 0x7622f983, v86
    v_fract_f32 v86, v86
    v_cos_f32 v86, v86
    v_xor_b32 v90, 8, v121
    v_xor_b32 v91, 16, v121
    v_xor_b32 v92, 24, v121
    v_add_f32 v88, v86, v86
    v_fma_f32 v87, v88, v86, -1.0
    v_fma_f32 v88, v88, v87, -v86
    v_pk_mul_f32 v[38:39], v[38:39], v[86:87] op_sel:[0,0] op_sel_hi:[1,0]
    v_pk_mul_f32 v[40:41], v[40:41], v[86:87] op_sel:[0,0] op_sel_hi:[1,0]
    v_pk_fma_f32 v[38:39], v[42:43], v[86:87], v[38:39] op_sel:[0,1,0] op_sel_hi:[1,1,1]
    v_pk_fma_f32 v[40:41], v[44:45], v[86:87], v[40:41] op_sel:[0,1,0] op_sel_hi:[1,1,1]
    v_pk_fma_f32 v[38:39], v[46:47], v[88:89], v[38:39] op_sel:[0,0,0] op_sel_hi:[1,0,1]
    v_pk_fma_f32 v[40:41], v[48:49], v[88:89], v[40:41] op_sel:[0,0,0] op_sel_hi:[1,0,1]
    v_pk_mul_f32 v[38:39], v[38:39], v[50:51]
    v_pk_mul_f32 v[40:41], v[40:41], v[52:53]
    v_cvt_f64_f32 v[46:47], v38
    ds_add_f64 v121, v[46:47] offset:2048
    v_cvt_f64_f32 v[48:49], v39
    ds_add_f64 v90, v[48:49] offset:2048
    v_cvt_f64_f32 v[50:51], v40
    ds_add_f64 v91, v[50:51] offset:2048
    v_cvt_f64_f32 v[52:53], v41
    ds_add_f64 v92, v[52:53] offset:2048
    s_mov_b64 exec, -1
    s_waitcnt vmcnt(3) lgkmcnt(4)
    v_mfma_f32_4x4x4_16b_bf16 v[38:41], v[58:59], v[54:55], 0
    v_mfma_f32_4x4x4_16b_bf16 v[42:45], v[62:63], v[54:55], 0
    v_mfma_f32_4x4x4_16b_bf16 v[46:49], v[66:67], v[54:55], 0
    v_mfma_f32_4x4x4_16b_bf16 v[50:53], v[70:71], v[74:75], 0
    v_mfma_f32_4x4x4_16b_bf16 v[38:41], v[60:61], v[56:57], v[38:41]
    v_mfma_f32_4x4x4_16b_bf16 v[42:45], v[64:65], v[56:57], v[42:45]
    v_mfma_f32_4x4x4_16b_bf16 v[46:49], v[68:69], v[56:57], v[46:49]
    v_lshrrev_b32 v119, 3, v4
    v_bitop3_b32 v121, v119, v112, v111 bitop3:0xea
    v_and_b32 v94, -9, v121
    ds_read_b128 v[54:57], v94 offset:42240
    v_cmpx_ne_u32 vcc, v3, v84
    v_and_b32 v86, 0x1fff0000, v120
    v_mul_f32 v86, 0x7622f983, v86
    v_fract_f32 v86, v86
    v_cos_f32 v86, v86
    v_xor_b32 v90, 8, v122
    v_xor_b32 v91, 16, v122
    v_xor_b32 v92, 24, v122
    v_add_f32 v88, v86, v86
    v_fma_f32 v87, v88, v86, -1.0
    v_fma_f32 v88, v88, v87, -v86
    v_pk_mul_f32 v[38:39], v[38:39], v[86:87] op_sel:[0,0] op_sel_hi:[1,0]
    v_pk_mul_f32 v[40:41], v[40:41], v[86:87] op_sel:[0,0] op_sel_hi:[1,0]
    v_pk_fma_f32 v[38:39], v[42:43], v[86:87], v[38:39] op_sel:[0,1,0] op_sel_hi:[1,1,1]
    v_pk_fma_f32 v[40:41], v[44:45], v[86:87], v[40:41] op_sel:[0,1,0] op_sel_hi:[1,1,1]
    v_pk_fma_f32 v[38:39], v[46:47], v[88:89], v[38:39] op_sel:[0,0,0] op_sel_hi:[1,0,1]
    v_pk_fma_f32 v[40:41], v[48:49], v[88:89], v[40:41] op_sel:[0,0,0] op_sel_hi:[1,0,1]
    v_pk_mul_f32 v[38:39], v[38:39], v[50:51]
    v_pk_mul_f32 v[40:41], v[40:41], v[52:53]
    v_cvt_f64_f32 v[46:47], v38
    ds_add_f64 v122, v[46:47] offset:2048
    v_cvt_f64_f32 v[48:49], v39
    ds_add_f64 v90, v[48:49] offset:2048
    v_cvt_f64_f32 v[50:51], v40
    ds_add_f64 v91, v[50:51] offset:2048
    v_cvt_f64_f32 v[52:53], v41
    ds_add_f64 v92, v[52:53] offset:2048
    s_mov_b64 exec, -1
    v_and_b32 v95, 0x3ff, v6
    buffer_load_dwordx2 v[72:73], v95, s[8:11], s39 idxen
    v_and_b32 v95, 0x3ff, v7
    buffer_load_dwordx2 v[74:75], v95, s[8:11], s39 idxen
    s_add_u32 s39, s39, 106752
    s_waitcnt vmcnt(4)
    v_readfirstlane_b32 s35, v118
    s_sub_u32 s43, s35, s36
    s_min_u32 s43, s43, 512
    s_sub_u32 s35, s35, s43
    v_mov_b32 v26, v84
    v_mov_b32 v27, 0x7ffffff0
    v_lshlrev_b32 v89, 3, v115
    v_add_u32 v93, s35, v89
    v_cmpx_gt_u32 vcc, s43, v89
    ds_read_b64 v[26:27], v93
    s_mov_b64 exec, -1
    s_waitcnt lgkmcnt(0)
    v_lshrrev_b32 v89, 4, v27
    v_subrev_u32 v89, 4, v89
    v_min_u32 v89, 0x1000, v89
    v_mul_u32_u24 v89, 834, v89
    v_and_b32 v93, 0x3ff, v26
    v_add_lshl_u32 v89, v89, v93, 3
    buffer_load_dwordx2 v[28:29], v89, s[12:15], 0 offen
    s_setprio 2
    v_lshlrev_b32 v18, 4, v0
    s_mul_i32 s41, s32, 10000
    buffer_load_dwordx4 v[20:23], v18, s[12:15], s41 offen
    s_waitcnt vmcnt(5)
    v_mfma_f32_4x4x4_16b_bf16 v[38:41], v[58:59], v[54:55], 0
    v_mfma_f32_4x4x4_16b_bf16 v[42:45], v[62:63], v[54:55], 0
    v_mfma_f32_4x4x4_16b_bf16 v[46:49], v[66:67], v[54:55], 0
    v_mfma_f32_4x4x4_16b_bf16 v[50:53], v[70:71], v[76:77], 0
    v_mfma_f32_4x4x4_16b_bf16 v[38:41], v[60:61], v[56:57], v[38:41]
    v_mfma_f32_4x4x4_16b_bf16 v[42:45], v[64:65], v[56:57], v[42:45]
    v_mfma_f32_4x4x4_16b_bf16 v[46:49], v[68:69], v[56:57], v[46:49]
    v_lshrrev_b32 v120, 3, v5
    v_bitop3_b32 v122, v120, v112, v111 bitop3:0xea
    v_and_b32 v94, -9, v122
    ds_read_b128 v[54:57], v94 offset:42240
    v_cmpx_ne_u32 vcc, v4, v84
    v_and_b32 v86, 0x1fff0000, v119
    v_mul_f32 v86, 0x7622f983, v86
    v_fract_f32 v86, v86
    v_cos_f32 v86, v86
    v_xor_b32 v90, 8, v121
    v_xor_b32 v91, 16, v121
    v_xor_b32 v92, 24, v121
    v_add_f32 v88, v86, v86
    v_fma_f32 v87, v88, v86, -1.0
    v_fma_f32 v88, v88, v87, -v86
    v_pk_mul_f32 v[38:39], v[38:39], v[86:87] op_sel:[0,0] op_sel_hi:[1,0]
    v_pk_mul_f32 v[40:41], v[40:41], v[86:87] op_sel:[0,0] op_sel_hi:[1,0]
    v_pk_fma_f32 v[38:39], v[42:43], v[86:87], v[38:39] op_sel:[0,1,0] op_sel_hi:[1,1,1]
    v_pk_fma_f32 v[40:41], v[44:45], v[86:87], v[40:41] op_sel:[0,1,0] op_sel_hi:[1,1,1]
    v_pk_fma_f32 v[38:39], v[46:47], v[88:89], v[38:39] op_sel:[0,0,0] op_sel_hi:[1,0,1]
    v_pk_fma_f32 v[40:41], v[48:49], v[88:89], v[40:41] op_sel:[0,0,0] op_sel_hi:[1,0,1]
    v_pk_mul_f32 v[38:39], v[38:39], v[50:51]
    v_pk_mul_f32 v[40:41], v[40:41], v[52:53]
    v_cvt_f64_f32 v[46:47], v38
    ds_add_f64 v121, v[46:47] offset:2048
    v_cvt_f64_f32 v[48:49], v39
    ds_add_f64 v90, v[48:49] offset:2048
    v_cvt_f64_f32 v[50:51], v40
    ds_add_f64 v91, v[50:51] offset:2048
    v_cvt_f64_f32 v[52:53], v41
    ds_add_f64 v92, v[52:53] offset:2048
    s_mov_b64 exec, -1
    s_waitcnt vmcnt(4) lgkmcnt(4)
    v_mfma_f32_4x4x4_16b_bf16 v[38:41], v[58:59], v[54:55], 0
    v_mfma_f32_4x4x4_16b_bf16 v[42:45], v[62:63], v[54:55], 0
    v_mfma_f32_4x4x4_16b_bf16 v[46:49], v[66:67], v[54:55], 0
    v_mfma_f32_4x4x4_16b_bf16 v[50:53], v[70:71], v[78:79], 0
    v_mfma_f32_4x4x4_16b_bf16 v[38:41], v[60:61], v[56:57], v[38:41]
    v_mfma_f32_4x4x4_16b_bf16 v[42:45], v[64:65], v[56:57], v[42:45]
    v_mfma_f32_4x4x4_16b_bf16 v[46:49], v[68:69], v[56:57], v[46:49]
    v_lshrrev_b32 v119, 3, v6
    v_bitop3_b32 v121, v119, v112, v111 bitop3:0xea
    v_and_b32 v94, -9, v121
    ds_read_b128 v[54:57], v94 offset:42240
    v_cmpx_ne_u32 vcc, v5, v84
    v_and_b32 v86, 0x1fff0000, v120
    v_mul_f32 v86, 0x7622f983, v86
    v_fract_f32 v86, v86
    v_cos_f32 v86, v86
    v_xor_b32 v90, 8, v122
    v_xor_b32 v91, 16, v122
    v_xor_b32 v92, 24, v122
    v_add_f32 v88, v86, v86
    v_fma_f32 v87, v88, v86, -1.0
    v_fma_f32 v88, v88, v87, -v86
    v_pk_mul_f32 v[38:39], v[38:39], v[86:87] op_sel:[0,0] op_sel_hi:[1,0]
    v_pk_mul_f32 v[40:41], v[40:41], v[86:87] op_sel:[0,0] op_sel_hi:[1,0]
    v_pk_fma_f32 v[38:39], v[42:43], v[86:87], v[38:39] op_sel:[0,1,0] op_sel_hi:[1,1,1]
    v_pk_fma_f32 v[40:41], v[44:45], v[86:87], v[40:41] op_sel:[0,1,0] op_sel_hi:[1,1,1]
    v_pk_fma_f32 v[38:39], v[46:47], v[88:89], v[38:39] op_sel:[0,0,0] op_sel_hi:[1,0,1]
    v_pk_fma_f32 v[40:41], v[48:49], v[88:89], v[40:41] op_sel:[0,0,0] op_sel_hi:[1,0,1]
    v_pk_mul_f32 v[38:39], v[38:39], v[50:51]
    v_pk_mul_f32 v[40:41], v[40:41], v[52:53]
    v_cvt_f64_f32 v[46:47], v38
    ds_add_f64 v122, v[46:47] offset:2048
    v_cvt_f64_f32 v[48:49], v39
    ds_add_f64 v90, v[48:49] offset:2048
    v_cvt_f64_f32 v[50:51], v40
    ds_add_f64 v91, v[50:51] offset:2048
    v_cvt_f64_f32 v[52:53], v41
    ds_add_f64 v92, v[52:53] offset:2048
    s_mov_b64 exec, -1
    v_and_b32 v95, 0x3ff, v8
    buffer_load_dwordx2 v[76:77], v95, s[8:11], s39 idxen
    v_and_b32 v95, 0x3ff, v9
    buffer_load_dwordx2 v[78:79], v95, s[8:11], s39 idxen
    s_add_u32 s39, s39, 106752
    s_waitcnt vmcnt(5) lgkmcnt(4)
    v_mfma_f32_4x4x4_16b_bf16 v[38:41], v[58:59], v[54:55], 0
    v_mfma_f32_4x4x4_16b_bf16 v[42:45], v[62:63], v[54:55], 0
    v_mfma_f32_4x4x4_16b_bf16 v[46:49], v[66:67], v[54:55], 0
    v_mfma_f32_4x4x4_16b_bf16 v[50:53], v[70:71], v[72:73], 0
    v_mfma_f32_4x4x4_16b_bf16 v[38:41], v[60:61], v[56:57], v[38:41]
    v_mfma_f32_4x4x4_16b_bf16 v[42:45], v[64:65], v[56:57], v[42:45]
    v_mfma_f32_4x4x4_16b_bf16 v[46:49], v[68:69], v[56:57], v[46:49]
    v_lshrrev_b32 v120, 3, v7
    v_bitop3_b32 v122, v120, v112, v111 bitop3:0xea
    v_and_b32 v94, -9, v122
    ds_read_b128 v[54:57], v94 offset:42240
    v_cmpx_ne_u32 vcc, v6, v84
    v_and_b32 v86, 0x1fff0000, v119
    v_mul_f32 v86, 0x7622f983, v86
    v_fract_f32 v86, v86
    v_cos_f32 v86, v86
    v_xor_b32 v90, 8, v121
    v_xor_b32 v91, 16, v121
    v_xor_b32 v92, 24, v121
    v_add_f32 v88, v86, v86
    v_fma_f32 v87, v88, v86, -1.0
    v_fma_f32 v88, v88, v87, -v86
    v_pk_mul_f32 v[38:39], v[38:39], v[86:87] op_sel:[0,0] op_sel_hi:[1,0]
    v_pk_mul_f32 v[40:41], v[40:41], v[86:87] op_sel:[0,0] op_sel_hi:[1,0]
    v_pk_fma_f32 v[38:39], v[42:43], v[86:87], v[38:39] op_sel:[0,1,0] op_sel_hi:[1,1,1]
    v_pk_fma_f32 v[40:41], v[44:45], v[86:87], v[40:41] op_sel:[0,1,0] op_sel_hi:[1,1,1]
    v_pk_fma_f32 v[38:39], v[46:47], v[88:89], v[38:39] op_sel:[0,0,0] op_sel_hi:[1,0,1]
    v_pk_fma_f32 v[40:41], v[48:49], v[88:89], v[40:41] op_sel:[0,0,0] op_sel_hi:[1,0,1]
    v_pk_mul_f32 v[38:39], v[38:39], v[50:51]
    v_pk_mul_f32 v[40:41], v[40:41], v[52:53]
    v_cvt_f64_f32 v[46:47], v38
    ds_add_f64 v121, v[46:47] offset:2048
    v_cvt_f64_f32 v[48:49], v39
    ds_add_f64 v90, v[48:49] offset:2048
    v_cvt_f64_f32 v[50:51], v40
    ds_add_f64 v91, v[50:51] offset:2048
    v_cvt_f64_f32 v[52:53], v41
    ds_add_f64 v92, v[52:53] offset:2048
    s_mov_b64 exec, -1
    s_waitcnt vmcnt(4) lgkmcnt(4)
    v_mfma_f32_4x4x4_16b_bf16 v[38:41], v[58:59], v[54:55], 0
    v_mfma_f32_4x4x4_16b_bf16 v[42:45], v[62:63], v[54:55], 0
    v_mfma_f32_4x4x4_16b_bf16 v[46:49], v[66:67], v[54:55], 0
    v_mfma_f32_4x4x4_16b_bf16 v[50:53], v[70:71], v[74:75], 0
    v_mfma_f32_4x4x4_16b_bf16 v[38:41], v[60:61], v[56:57], v[38:41]
    v_mfma_f32_4x4x4_16b_bf16 v[42:45], v[64:65], v[56:57], v[42:45]
    v_mfma_f32_4x4x4_16b_bf16 v[46:49], v[68:69], v[56:57], v[46:49]
    v_lshrrev_b32 v119, 3, v8
    v_bitop3_b32 v121, v119, v112, v111 bitop3:0xea
    v_and_b32 v94, -9, v121
    ds_read_b128 v[54:57], v94 offset:42240
    v_cmpx_ne_u32 vcc, v7, v84
    v_and_b32 v86, 0x1fff0000, v120
    v_mul_f32 v86, 0x7622f983, v86
    v_fract_f32 v86, v86
    v_cos_f32 v86, v86
    v_xor_b32 v90, 8, v122
    v_xor_b32 v91, 16, v122
    v_xor_b32 v92, 24, v122
    v_add_f32 v88, v86, v86
    v_fma_f32 v87, v88, v86, -1.0
    v_fma_f32 v88, v88, v87, -v86
    v_pk_mul_f32 v[38:39], v[38:39], v[86:87] op_sel:[0,0] op_sel_hi:[1,0]
    v_pk_mul_f32 v[40:41], v[40:41], v[86:87] op_sel:[0,0] op_sel_hi:[1,0]
    v_pk_fma_f32 v[38:39], v[42:43], v[86:87], v[38:39] op_sel:[0,1,0] op_sel_hi:[1,1,1]
    v_pk_fma_f32 v[40:41], v[44:45], v[86:87], v[40:41] op_sel:[0,1,0] op_sel_hi:[1,1,1]
    v_pk_fma_f32 v[38:39], v[46:47], v[88:89], v[38:39] op_sel:[0,0,0] op_sel_hi:[1,0,1]
    v_pk_fma_f32 v[40:41], v[48:49], v[88:89], v[40:41] op_sel:[0,0,0] op_sel_hi:[1,0,1]
    v_pk_mul_f32 v[38:39], v[38:39], v[50:51]
    v_pk_mul_f32 v[40:41], v[40:41], v[52:53]
    v_cvt_f64_f32 v[46:47], v38
    ds_add_f64 v122, v[46:47] offset:2048
    v_cvt_f64_f32 v[48:49], v39
    ds_add_f64 v90, v[48:49] offset:2048
    v_cvt_f64_f32 v[50:51], v40
    ds_add_f64 v91, v[50:51] offset:2048
    v_cvt_f64_f32 v[52:53], v41
    ds_add_f64 v92, v[52:53] offset:2048
    s_mov_b64 exec, -1
    v_and_b32 v95, 0x3ff, v10
    buffer_load_dwordx2 v[72:73], v95, s[8:11], s39 idxen
    v_and_b32 v95, 0x3ff, v11
    buffer_load_dwordx2 v[74:75], v95, s[8:11], s39 idxen
    s_add_u32 s39, s39, 106752
    s_waitcnt vmcnt(3) lgkmcnt(4)
    v_mfma_f32_4x4x4_16b_bf16 v[38:41], v[58:59], v[54:55], 0
    v_mfma_f32_4x4x4_16b_bf16 v[42:45], v[62:63], v[54:55], 0
    v_mfma_f32_4x4x4_16b_bf16 v[46:49], v[66:67], v[54:55], 0
    v_mfma_f32_4x4x4_16b_bf16 v[50:53], v[70:71], v[76:77], 0
    v_mfma_f32_4x4x4_16b_bf16 v[38:41], v[60:61], v[56:57], v[38:41]
    v_mfma_f32_4x4x4_16b_bf16 v[42:45], v[64:65], v[56:57], v[42:45]
    v_mfma_f32_4x4x4_16b_bf16 v[46:49], v[68:69], v[56:57], v[46:49]
    v_lshrrev_b32 v120, 3, v9
    v_bitop3_b32 v122, v120, v112, v111 bitop3:0xea
    v_and_b32 v94, -9, v122
    ds_read_b128 v[54:57], v94 offset:42240
    v_cmpx_ne_u32 vcc, v8, v84
    v_and_b32 v86, 0x1fff0000, v119
    v_mul_f32 v86, 0x7622f983, v86
    v_fract_f32 v86, v86
    v_cos_f32 v86, v86
    v_xor_b32 v90, 8, v121
    v_xor_b32 v91, 16, v121
    v_xor_b32 v92, 24, v121
    v_add_f32 v88, v86, v86
    v_fma_f32 v87, v88, v86, -1.0
    v_fma_f32 v88, v88, v87, -v86
    v_pk_mul_f32 v[38:39], v[38:39], v[86:87] op_sel:[0,0] op_sel_hi:[1,0]
    v_pk_mul_f32 v[40:41], v[40:41], v[86:87] op_sel:[0,0] op_sel_hi:[1,0]
    v_pk_fma_f32 v[38:39], v[42:43], v[86:87], v[38:39] op_sel:[0,1,0] op_sel_hi:[1,1,1]
    v_pk_fma_f32 v[40:41], v[44:45], v[86:87], v[40:41] op_sel:[0,1,0] op_sel_hi:[1,1,1]
    v_pk_fma_f32 v[38:39], v[46:47], v[88:89], v[38:39] op_sel:[0,0,0] op_sel_hi:[1,0,1]
    v_pk_fma_f32 v[40:41], v[48:49], v[88:89], v[40:41] op_sel:[0,0,0] op_sel_hi:[1,0,1]
    v_pk_mul_f32 v[38:39], v[38:39], v[50:51]
    v_pk_mul_f32 v[40:41], v[40:41], v[52:53]
    v_cvt_f64_f32 v[46:47], v38
    ds_add_f64 v121, v[46:47] offset:2048
    v_cvt_f64_f32 v[48:49], v39
    ds_add_f64 v90, v[48:49] offset:2048
    v_cvt_f64_f32 v[50:51], v40
    ds_add_f64 v91, v[50:51] offset:2048
    v_cvt_f64_f32 v[52:53], v41
    ds_add_f64 v92, v[52:53] offset:2048
    s_mov_b64 exec, -1
    s_cmp_eq_u32 s43, 0
    s_cbranch_scc1 acc_gf1
    v_lshrrev_b32 v89, 3, v26
    v_and_b32 v93, 0xff80, v89
    v_and_b32 v27, 12, v27
    v_lshl_add_u32 v93, v27, 3, v93
    ds_read_b128 v[54:57], v93 offset:42240
    v_and_or_b32 v93, v111, 24, v93
    s_waitcnt lgkmcnt(0)
    v_mfma_f32_4x4x4_16b_bf16 v[38:41], v[58:59], v[54:55], 0
    v_mfma_f32_4x4x4_16b_bf16 v[42:45], v[62:63], v[54:55], 0
    v_mfma_f32_4x4x4_16b_bf16 v[46:49], v[66:67], v[54:55], 0
    v_mfma_f32_4x4x4_16b_bf16 v[50:53], v[70:71], v[28:29], 0
    v_mfma_f32_4x4x4_16b_bf16 v[38:41], v[60:61], v[56:57], v[38:41]
    v_mfma_f32_4x4x4_16b_bf16 v[42:45], v[64:65], v[56:57], v[42:45]
    v_mfma_f32_4x4x4_16b_bf16 v[46:49], v[68:69], v[56:57], v[46:49]
    v_and_b32 v86, 0x1fff0000, v89
    v_mul_f32 v86, 0x7622f983, v86
    v_fract_f32 v86, v86
    v_cos_f32 v86, v86
    v_xor_b32 v90, 8, v93
    v_xor_b32 v91, 16, v93
    v_xor_b32 v92, 24, v93
    v_add_f32 v88, v86, v86
    v_fma_f32 v87, v88, v86, -1.0
    v_fma_f32 v88, v88, v87, -v86
    v_pk_mul_f32 v[38:39], v[38:39], v[86:87] op_sel:[0,0] op_sel_hi:[1,0]
    v_pk_mul_f32 v[40:41], v[40:41], v[86:87] op_sel:[0,0] op_sel_hi:[1,0]
    v_pk_fma_f32 v[38:39], v[42:43], v[86:87], v[38:39] op_sel:[0,1,0] op_sel_hi:[1,1,1]
    v_pk_fma_f32 v[40:41], v[44:45], v[86:87], v[40:41] op_sel:[0,1,0] op_sel_hi:[1,1,1]
    v_pk_fma_f32 v[38:39], v[46:47], v[88:89], v[38:39] op_sel:[0,0,0] op_sel_hi:[1,0,1]
    v_pk_fma_f32 v[40:41], v[48:49], v[88:89], v[40:41] op_sel:[0,0,0] op_sel_hi:[1,0,1]
    v_pk_mul_f32 v[38:39], v[38:39], v[50:51]
    v_pk_mul_f32 v[40:41], v[40:41], v[52:53]
    v_cmpx_ne_u32 vcc, v26, v84
    v_cvt_f64_f32 v[46:47], v38
    ds_add_f64 v93, v[46:47] offset:2048
    v_cvt_f64_f32 v[48:49], v39
    ds_add_f64 v90, v[48:49] offset:2048
    v_cvt_f64_f32 v[50:51], v40
    ds_add_f64 v91, v[50:51] offset:2048
    v_cvt_f64_f32 v[52:53], v41
    ds_add_f64 v92, v[52:53] offset:2048
    s_mov_b64 exec, -1
    v_lshrrev_b32 v120, 3, v9
    v_bitop3_b32 v122, v120, v112, v111 bitop3:0xea
    v_and_b32 v94, -9, v122
    ds_read_b128 v[54:57], v94 offset:42240
    s_waitcnt lgkmcnt(0)
acc_gf1:
    s_sub_u32 s43, s35, s36
    s_min_u32 s43, s43, 512
    s_sub_u32 s35, s35, s43
    v_mov_b32 v26, v84
    v_mov_b32 v27, 0x7ffffff0
    v_lshlrev_b32 v89, 3, v115
    v_add_u32 v93, s35, v89
    v_cmpx_gt_u32 vcc, s43, v89
    ds_read_b64 v[26:27], v93
    s_mov_b64 exec, -1
    s_waitcnt lgkmcnt(0)
    v_lshrrev_b32 v89, 4, v27
    v_subrev_u32 v89, 4, v89
    v_min_u32 v89, 0x1000, v89
    v_mul_u32_u24 v89, 834, v89
    v_and_b32 v93, 0x3ff, v26
    v_add_lshl_u32 v89, v89, v93, 3
    buffer_load_dwordx2 v[28:29], v89, s[12:15], 0 offen
    s_setprio 1
    s_waitcnt vmcnt(3)
    v_mfma_f32_4x4x4_16b_bf16 v[38:41], v[58:59], v[54:55], 0
    v_mfma_f32_4x4x4_16b_bf16 v[42:45], v[62:63], v[54:55], 0
    v_mfma_f32_4x4x4_16b_bf16 v[46:49], v[66:67], v[54:55], 0
    v_mfma_f32_4x4x4_16b_bf16 v[50:53], v[70:71], v[78:79], 0
    v_mfma_f32_4x4x4_16b_bf16 v[38:41], v[60:61], v[56:57], v[38:41]
    v_mfma_f32_4x4x4_16b_bf16 v[42:45], v[64:65], v[56:57], v[42:45]
    v_mfma_f32_4x4x4_16b_bf16 v[46:49], v[68:69], v[56:57], v[46:49]
    v_lshrrev_b32 v119, 3, v10
    v_bitop3_b32 v121, v119, v112, v111 bitop3:0xea
    v_and_b32 v94, -9, v121
    ds_read_b128 v[54:57], v94 offset:42240
    v_cmpx_ne_u32 vcc, v9, v84
    v_and_b32 v86, 0x1fff0000, v120
    v_mul_f32 v86, 0x7622f983, v86
    v_fract_f32 v86, v86
    v_cos_f32 v86, v86
    v_xor_b32 v90, 8, v122
    v_xor_b32 v91, 16, v122
    v_xor_b32 v92, 24, v122
    v_add_f32 v88, v86, v86
    v_fma_f32 v87, v88, v86, -1.0
    v_fma_f32 v88, v88, v87, -v86
    v_pk_mul_f32 v[38:39], v[38:39], v[86:87] op_sel:[0,0] op_sel_hi:[1,0]
    v_pk_mul_f32 v[40:41], v[40:41], v[86:87] op_sel:[0,0] op_sel_hi:[1,0]
    v_pk_fma_f32 v[38:39], v[42:43], v[86:87], v[38:39] op_sel:[0,1,0] op_sel_hi:[1,1,1]
    v_pk_fma_f32 v[40:41], v[44:45], v[86:87], v[40:41] op_sel:[0,1,0] op_sel_hi:[1,1,1]
    v_pk_fma_f32 v[38:39], v[46:47], v[88:89], v[38:39] op_sel:[0,0,0] op_sel_hi:[1,0,1]
    v_pk_fma_f32 v[40:41], v[48:49], v[88:89], v[40:41] op_sel:[0,0,0] op_sel_hi:[1,0,1]
    v_pk_mul_f32 v[38:39], v[38:39], v[50:51]
    v_pk_mul_f32 v[40:41], v[40:41], v[52:53]
    v_cvt_f64_f32 v[46:47], v38
    ds_add_f64 v122, v[46:47] offset:2048
    v_cvt_f64_f32 v[48:49], v39
    ds_add_f64 v90, v[48:49] offset:2048
    v_cvt_f64_f32 v[50:51], v40
    ds_add_f64 v91, v[50:51] offset:2048
    v_cvt_f64_f32 v[52:53], v41
    ds_add_f64 v92, v[52:53] offset:2048
    s_mov_b64 exec, -1
    v_and_b32 v95, 0x3ff, v12
    buffer_load_dwordx2 v[76:77], v95, s[8:11], s39 idxen
    v_and_b32 v95, 0x3ff, v13
    buffer_load_dwordx2 v[78:79], v95, s[8:11], s39 idxen
    s_add_u32 s39, s39, 106752
    s_waitcnt vmcnt(4) lgkmcnt(4)
    v_mfma_f32_4x4x4_16b_bf16 v[38:41], v[58:59], v[54:55], 0
    v_mfma_f32_4x4x4_16b_bf16 v[42:45], v[62:63], v[54:55], 0
    v_mfma_f32_4x4x4_16b_bf16 v[46:49], v[66:67], v[54:55], 0
    v_mfma_f32_4x4x4_16b_bf16 v[50:53], v[70:71], v[72:73], 0
    v_mfma_f32_4x4x4_16b_bf16 v[38:41], v[60:61], v[56:57], v[38:41]
    v_mfma_f32_4x4x4_16b_bf16 v[42:45], v[64:65], v[56:57], v[42:45]
    v_mfma_f32_4x4x4_16b_bf16 v[46:49], v[68:69], v[56:57], v[46:49]
    v_lshrrev_b32 v120, 3, v11
    v_bitop3_b32 v122, v120, v112, v111 bitop3:0xea
    v_and_b32 v94, -9, v122
    ds_read_b128 v[54:57], v94 offset:42240
    v_cmpx_ne_u32 vcc, v10, v84
    v_and_b32 v86, 0x1fff0000, v119
    v_mul_f32 v86, 0x7622f983, v86
    v_fract_f32 v86, v86
    v_cos_f32 v86, v86
    v_xor_b32 v90, 8, v121
    v_xor_b32 v91, 16, v121
    v_xor_b32 v92, 24, v121
    v_add_f32 v88, v86, v86
    v_fma_f32 v87, v88, v86, -1.0
    v_fma_f32 v88, v88, v87, -v86
    v_pk_mul_f32 v[38:39], v[38:39], v[86:87] op_sel:[0,0] op_sel_hi:[1,0]
    v_pk_mul_f32 v[40:41], v[40:41], v[86:87] op_sel:[0,0] op_sel_hi:[1,0]
    v_pk_fma_f32 v[38:39], v[42:43], v[86:87], v[38:39] op_sel:[0,1,0] op_sel_hi:[1,1,1]
    v_pk_fma_f32 v[40:41], v[44:45], v[86:87], v[40:41] op_sel:[0,1,0] op_sel_hi:[1,1,1]
    v_pk_fma_f32 v[38:39], v[46:47], v[88:89], v[38:39] op_sel:[0,0,0] op_sel_hi:[1,0,1]
    v_pk_fma_f32 v[40:41], v[48:49], v[88:89], v[40:41] op_sel:[0,0,0] op_sel_hi:[1,0,1]
    v_pk_mul_f32 v[38:39], v[38:39], v[50:51]
    v_pk_mul_f32 v[40:41], v[40:41], v[52:53]
    v_cvt_f64_f32 v[46:47], v38
    ds_add_f64 v121, v[46:47] offset:2048
    v_cvt_f64_f32 v[48:49], v39
    ds_add_f64 v90, v[48:49] offset:2048
    v_cvt_f64_f32 v[50:51], v40
    ds_add_f64 v91, v[50:51] offset:2048
    v_cvt_f64_f32 v[52:53], v41
    ds_add_f64 v92, v[52:53] offset:2048
    s_mov_b64 exec, -1
    s_waitcnt vmcnt(3) lgkmcnt(4)
    v_mfma_f32_4x4x4_16b_bf16 v[38:41], v[58:59], v[54:55], 0
    v_mfma_f32_4x4x4_16b_bf16 v[42:45], v[62:63], v[54:55], 0
    v_mfma_f32_4x4x4_16b_bf16 v[46:49], v[66:67], v[54:55], 0
    v_mfma_f32_4x4x4_16b_bf16 v[50:53], v[70:71], v[74:75], 0
    v_mfma_f32_4x4x4_16b_bf16 v[38:41], v[60:61], v[56:57], v[38:41]
    v_mfma_f32_4x4x4_16b_bf16 v[42:45], v[64:65], v[56:57], v[42:45]
    v_mfma_f32_4x4x4_16b_bf16 v[46:49], v[68:69], v[56:57], v[46:49]
    v_lshrrev_b32 v119, 3, v12
    v_bitop3_b32 v121, v119, v112, v111 bitop3:0xea
    v_and_b32 v94, -9, v121
    ds_read_b128 v[54:57], v94 offset:42240
    v_cmpx_ne_u32 vcc, v11, v84
    v_and_b32 v86, 0x1fff0000, v120
    v_mul_f32 v86, 0x7622f983, v86
    v_fract_f32 v86, v86
    v_cos_f32 v86, v86
    v_xor_b32 v90, 8, v122
    v_xor_b32 v91, 16, v122
    v_xor_b32 v92, 24, v122
    v_add_f32 v88, v86, v86
    v_fma_f32 v87, v88, v86, -1.0
    v_fma_f32 v88, v88, v87, -v86
    v_pk_mul_f32 v[38:39], v[38:39], v[86:87] op_sel:[0,0] op_sel_hi:[1,0]
    v_pk_mul_f32 v[40:41], v[40:41], v[86:87] op_sel:[0,0] op_sel_hi:[1,0]
    v_pk_fma_f32 v[38:39], v[42:43], v[86:87], v[38:39] op_sel:[0,1,0] op_sel_hi:[1,1,1]
    v_pk_fma_f32 v[40:41], v[44:45], v[86:87], v[40:41] op_sel:[0,1,0] op_sel_hi:[1,1,1]
    v_pk_fma_f32 v[38:39], v[46:47], v[88:89], v[38:39] op_sel:[0,0,0] op_sel_hi:[1,0,1]
    v_pk_fma_f32 v[40:41], v[48:49], v[88:89], v[40:41] op_sel:[0,0,0] op_sel_hi:[1,0,1]
    v_pk_mul_f32 v[38:39], v[38:39], v[50:51]
    v_pk_mul_f32 v[40:41], v[40:41], v[52:53]
    v_cvt_f64_f32 v[46:47], v38
    ds_add_f64 v122, v[46:47] offset:2048
    v_cvt_f64_f32 v[48:49], v39
    ds_add_f64 v90, v[48:49] offset:2048
    v_cvt_f64_f32 v[50:51], v40
    ds_add_f64 v91, v[50:51] offset:2048
    v_cvt_f64_f32 v[52:53], v41
    ds_add_f64 v92, v[52:53] offset:2048
    s_mov_b64 exec, -1
    v_and_b32 v95, 0x3ff, v14
    buffer_load_dwordx2 v[72:73], v95, s[8:11], s39 idxen
    v_and_b32 v95, 0x3ff, v15
    buffer_load_dwordx2 v[74:75], v95, s[8:11], s39 idxen
    s_add_u32 s39, s39, 106752
    s_cmp_ge_u32 s33, 10
    s_cbranch_scc1 acc_nogate
    v_lshlrev_b32 v86, 6, v0
    ds_read_b128 v[38:41], v86 offset:42240
    ds_read_b128 v[42:45], v86 offset:42272
    s_lshl_b32 s72, s48, 16
    s_and_b32 s73, s48, 0xffff0000
    s_lshl_b32 s74, s49, 16
    s_and_b32 s75, s49, 0xffff0000
    s_lshl_b32 s76, s50, 16
    s_and_b32 s77, s50, 0xffff0000
    s_lshl_b32 s78, s51, 16
    s_and_b32 s79, s51, 0xffff0000
    s_lshl_b32 s80, s52, 16
    s_and_b32 s81, s52, 0xffff0000
    s_lshl_b32 s82, s53, 16
    s_and_b32 s83, s53, 0xffff0000
    s_lshl_b32 s84, s54, 16
    s_and_b32 s85, s54, 0xffff0000
    s_lshl_b32 s86, s55, 16
    s_and_b32 s87, s55, 0xffff0000
    s_waitcnt lgkmcnt(0)
    v_lshlrev_b32 v88, 16, v38
    v_lshlrev_b32 v89, 16, v42
    s_lshl_b32 s41, s56, 16
    v_mul_f32 v98, s41, v88
    v_mul_f32 v102, s41, v89
    s_and_b32 s41, s56, 0xffff0000
    v_mul_f32 v99, s41, v88
    v_mul_f32 v103, s41, v89
    s_lshl_b32 s41, s57, 16
    v_mul_f32 v100, s41, v88
    v_mul_f32 v104, s41, v89
    s_and_b32 s41, s57, 0xffff0000
    v_mul_f32 v101, s41, v88
    v_mul_f32 v105, s41, v89
    v_and_b32 v88, 0xffff0000, v38
    v_and_b32 v89, 0xffff0000, v42
    s_lshl_b32 s41, s58, 16
    v_fmac_f32 v98, s41, v88
    v_fmac_f32 v102, s41, v89
    s_and_b32 s41, s58, 0xffff0000
    v_fmac_f32 v99, s41, v88
    v_fmac_f32 v103, s41, v89
    s_lshl_b32 s41, s59, 16
    v_fmac_f32 v100, s41, v88
    v_fmac_f32 v104, s41, v89
    s_and_b32 s41, s59, 0xffff0000
    v_fmac_f32 v101, s41, v88
    v_fmac_f32 v105, s41, v89
    v_lshlrev_b32 v88, 16, v39
    v_lshlrev_b32 v89, 16, v43
    s_lshl_b32 s41, s60, 16
    v_fmac_f32 v98, s41, v88
    v_fmac_f32 v102, s41, v89
    s_and_b32 s41, s60, 0xffff0000
    v_fmac_f32 v99, s41, v88
    v_fmac_f32 v103, s41, v89
    s_lshl_b32 s41, s61, 16
    v_fmac_f32 v100, s41, v88
    v_fmac_f32 v104, s41, v89
    s_and_b32 s41, s61, 0xffff0000
    v_fmac_f32 v101, s41, v88
    v_fmac_f32 v105, s41, v89
    v_and_b32 v88, 0xffff0000, v39
    v_and_b32 v89, 0xffff0000, v43
    s_lshl_b32 s41, s62, 16
    v_fmac_f32 v98, s41, v88
    v_fmac_f32 v102, s41, v89
    s_and_b32 s41, s62, 0xffff0000
    v_fmac_f32 v99, s41, v88
    v_fmac_f32 v103, s41, v89
    s_lshl_b32 s41, s63, 16
    v_fmac_f32 v100, s41, v88
    v_fmac_f32 v104, s41, v89
    s_and_b32 s41, s63, 0xffff0000
    v_fmac_f32 v101, s41, v88
    v_fmac_f32 v105, s41, v89
    v_lshlrev_b32 v88, 16, v40
    v_lshlrev_b32 v89, 16, v44
    s_lshl_b32 s41, s64, 16
    v_fmac_f32 v98, s41, v88
    v_fmac_f32 v102, s41, v89
    s_and_b32 s41, s64, 0xffff0000
    v_fmac_f32 v99, s41, v88
    v_fmac_f32 v103, s41, v89
    s_lshl_b32 s41, s65, 16
    v_fmac_f32 v100, s41, v88
    v_fmac_f32 v104, s41, v89
    s_and_b32 s41, s65, 0xffff0000
    v_fmac_f32 v101, s41, v88
    v_fmac_f32 v105, s41, v89
    v_and_b32 v88, 0xffff0000, v40
    v_and_b32 v89, 0xffff0000, v44
    s_lshl_b32 s41, s66, 16
    v_fmac_f32 v98, s41, v88
    v_fmac_f32 v102, s41, v89
    s_and_b32 s41, s66, 0xffff0000
    v_fmac_f32 v99, s41, v88
    v_fmac_f32 v103, s41, v89
    s_lshl_b32 s41, s67, 16
    v_fmac_f32 v100, s41, v88
    v_fmac_f32 v104, s41, v89
    s_and_b32 s41, s67, 0xffff0000
    v_fmac_f32 v101, s41, v88
    v_fmac_f32 v105, s41, v89
    v_lshlrev_b32 v88, 16, v41
    v_lshlrev_b32 v89, 16, v45
    s_lshl_b32 s41, s68, 16
    v_fmac_f32 v98, s41, v88
    v_fmac_f32 v102, s41, v89
    s_and_b32 s41, s68, 0xffff0000
    v_fmac_f32 v99, s41, v88
    v_fmac_f32 v103, s41, v89
    s_lshl_b32 s41, s69, 16
    v_fmac_f32 v100, s41, v88
    v_fmac_f32 v104, s41, v89
    s_and_b32 s41, s69, 0xffff0000
    v_fmac_f32 v101, s41, v88
    v_fmac_f32 v105, s41, v89
    v_and_b32 v88, 0xffff0000, v41
    v_and_b32 v89, 0xffff0000, v45
    s_lshl_b32 s41, s70, 16
    v_fmac_f32 v98, s41, v88
    v_fmac_f32 v102, s41, v89
    s_and_b32 s41, s70, 0xffff0000
    v_fmac_f32 v99, s41, v88
    v_fmac_f32 v103, s41, v89
    s_lshl_b32 s41, s71, 16
    v_fmac_f32 v100, s41, v88
    v_fmac_f32 v104, s41, v89
    s_and_b32 s41, s71, 0xffff0000
    v_fmac_f32 v101, s41, v88
    v_fmac_f32 v105, s41, v89
    v_lshlrev_b32 v30, 16, v20
    v_and_b32 v31, 0xffff0000, v20
    v_lshlrev_b32 v32, 16, v21
    v_and_b32 v33, 0xffff0000, v21
    v_lshlrev_b32 v34, 16, v22
    v_and_b32 v35, 0xffff0000, v22
    v_lshlrev_b32 v36, 16, v23
    v_and_b32 v37, 0xffff0000, v23
acc_nogate:
    s_waitcnt vmcnt(3) lgkmcnt(4)
    v_mfma_f32_4x4x4_16b_bf16 v[38:41], v[58:59], v[54:55], 0
    v_mfma_f32_4x4x4_16b_bf16 v[42:45], v[62:63], v[54:55], 0
    v_mfma_f32_4x4x4_16b_bf16 v[46:49], v[66:67], v[54:55], 0
    v_mfma_f32_4x4x4_16b_bf16 v[50:53], v[70:71], v[76:77], 0
    v_mfma_f32_4x4x4_16b_bf16 v[38:41], v[60:61], v[56:57], v[38:41]
    v_mfma_f32_4x4x4_16b_bf16 v[42:45], v[64:65], v[56:57], v[42:45]
    v_mfma_f32_4x4x4_16b_bf16 v[46:49], v[68:69], v[56:57], v[46:49]
    v_lshrrev_b32 v120, 3, v13
    v_bitop3_b32 v122, v120, v112, v111 bitop3:0xea
    v_and_b32 v94, -9, v122
    ds_read_b128 v[54:57], v94 offset:42240
    v_cmpx_ne_u32 vcc, v12, v84
    v_and_b32 v86, 0x1fff0000, v119
    v_mul_f32 v86, 0x7622f983, v86
    v_fract_f32 v86, v86
    v_cos_f32 v86, v86
    v_xor_b32 v90, 8, v121
    v_xor_b32 v91, 16, v121
    v_xor_b32 v92, 24, v121
    v_add_f32 v88, v86, v86
    v_fma_f32 v87, v88, v86, -1.0
    v_fma_f32 v88, v88, v87, -v86
    v_pk_mul_f32 v[38:39], v[38:39], v[86:87] op_sel:[0,0] op_sel_hi:[1,0]
    v_pk_mul_f32 v[40:41], v[40:41], v[86:87] op_sel:[0,0] op_sel_hi:[1,0]
    v_pk_fma_f32 v[38:39], v[42:43], v[86:87], v[38:39] op_sel:[0,1,0] op_sel_hi:[1,1,1]
    v_pk_fma_f32 v[40:41], v[44:45], v[86:87], v[40:41] op_sel:[0,1,0] op_sel_hi:[1,1,1]
    v_pk_fma_f32 v[38:39], v[46:47], v[88:89], v[38:39] op_sel:[0,0,0] op_sel_hi:[1,0,1]
    v_pk_fma_f32 v[40:41], v[48:49], v[88:89], v[40:41] op_sel:[0,0,0] op_sel_hi:[1,0,1]
    v_pk_mul_f32 v[38:39], v[38:39], v[50:51]
    v_pk_mul_f32 v[40:41], v[40:41], v[52:53]
    v_cvt_f64_f32 v[46:47], v38
    ds_add_f64 v121, v[46:47] offset:2048
    v_cvt_f64_f32 v[48:49], v39
    ds_add_f64 v90, v[48:49] offset:2048
    v_cvt_f64_f32 v[50:51], v40
    ds_add_f64 v91, v[50:51] offset:2048
    v_cvt_f64_f32 v[52:53], v41
    ds_add_f64 v92, v[52:53] offset:2048
    s_mov_b64 exec, -1
    s_waitcnt vmcnt(2) lgkmcnt(4)
    v_mfma_f32_4x4x4_16b_bf16 v[38:41], v[58:59], v[54:55], 0
    v_mfma_f32_4x4x4_16b_bf16 v[42:45], v[62:63], v[54:55], 0
    v_mfma_f32_4x4x4_16b_bf16 v[46:49], v[66:67], v[54:55], 0
    v_mfma_f32_4x4x4_16b_bf16 v[50:53], v[70:71], v[78:79], 0
    v_mfma_f32_4x4x4_16b_bf16 v[38:41], v[60:61], v[56:57], v[38:41]
    v_mfma_f32_4x4x4_16b_bf16 v[42:45], v[64:65], v[56:57], v[42:45]
    v_mfma_f32_4x4x4_16b_bf16 v[46:49], v[68:69], v[56:57], v[46:49]
    v_lshrrev_b32 v119, 3, v14
    v_bitop3_b32 v121, v119, v112, v111 bitop3:0xea
    v_and_b32 v94, -9, v121
    ds_read_b128 v[54:57], v94 offset:42240
    v_cmpx_ne_u32 vcc, v13, v84
    v_and_b32 v86, 0x1fff0000, v120
    v_mul_f32 v86, 0x7622f983, v86
    v_fract_f32 v86, v86
    v_cos_f32 v86, v86
    v_xor_b32 v90, 8, v122
    v_xor_b32 v91, 16, v122
    v_xor_b32 v92, 24, v122
    v_add_f32 v88, v86, v86
    v_fma_f32 v87, v88, v86, -1.0
    v_fma_f32 v88, v88, v87, -v86
    v_pk_mul_f32 v[38:39], v[38:39], v[86:87] op_sel:[0,0] op_sel_hi:[1,0]
    v_pk_mul_f32 v[40:41], v[40:41], v[86:87] op_sel:[0,0] op_sel_hi:[1,0]
    v_pk_fma_f32 v[38:39], v[42:43], v[86:87], v[38:39] op_sel:[0,1,0] op_sel_hi:[1,1,1]
    v_pk_fma_f32 v[40:41], v[44:45], v[86:87], v[40:41] op_sel:[0,1,0] op_sel_hi:[1,1,1]
    v_pk_fma_f32 v[38:39], v[46:47], v[88:89], v[38:39] op_sel:[0,0,0] op_sel_hi:[1,0,1]
    v_pk_fma_f32 v[40:41], v[48:49], v[88:89], v[40:41] op_sel:[0,0,0] op_sel_hi:[1,0,1]
    v_pk_mul_f32 v[38:39], v[38:39], v[50:51]
    v_pk_mul_f32 v[40:41], v[40:41], v[52:53]
    v_cvt_f64_f32 v[46:47], v38
    ds_add_f64 v122, v[46:47] offset:2048
    v_cvt_f64_f32 v[48:49], v39
    ds_add_f64 v90, v[48:49] offset:2048
    v_cvt_f64_f32 v[50:51], v40
    ds_add_f64 v91, v[50:51] offset:2048
    v_cvt_f64_f32 v[52:53], v41
    ds_add_f64 v92, v[52:53] offset:2048
    s_mov_b64 exec, -1
    v_and_b32 v95, 0x3ff, v16
    buffer_load_dwordx2 v[76:77], v95, s[8:11], s39 idxen
    v_and_b32 v95, 0x3ff, v17
    buffer_load_dwordx2 v[78:79], v95, s[8:11], s39 idxen
    s_add_u32 s39, s39, 106752
    s_cmp_eq_u32 s43, 0
    s_cbranch_scc1 acc_gf2
    v_lshrrev_b32 v89, 3, v26
    v_and_b32 v93, 0xff80, v89
    v_and_b32 v27, 12, v27
    v_lshl_add_u32 v93, v27, 3, v93
    ds_read_b128 v[54:57], v93 offset:42240
    v_and_or_b32 v93, v111, 24, v93
    s_waitcnt lgkmcnt(0)
    v_mfma_f32_4x4x4_16b_bf16 v[38:41], v[58:59], v[54:55], 0
    v_mfma_f32_4x4x4_16b_bf16 v[42:45], v[62:63], v[54:55], 0
    v_mfma_f32_4x4x4_16b_bf16 v[46:49], v[66:67], v[54:55], 0
    v_mfma_f32_4x4x4_16b_bf16 v[50:53], v[70:71], v[28:29], 0
    v_mfma_f32_4x4x4_16b_bf16 v[38:41], v[60:61], v[56:57], v[38:41]
    v_mfma_f32_4x4x4_16b_bf16 v[42:45], v[64:65], v[56:57], v[42:45]
    v_mfma_f32_4x4x4_16b_bf16 v[46:49], v[68:69], v[56:57], v[46:49]
    v_and_b32 v86, 0x1fff0000, v89
    v_mul_f32 v86, 0x7622f983, v86
    v_fract_f32 v86, v86
    v_cos_f32 v86, v86
    v_xor_b32 v90, 8, v93
    v_xor_b32 v91, 16, v93
    v_xor_b32 v92, 24, v93
    v_add_f32 v88, v86, v86
    v_fma_f32 v87, v88, v86, -1.0
    v_fma_f32 v88, v88, v87, -v86
    v_pk_mul_f32 v[38:39], v[38:39], v[86:87] op_sel:[0,0] op_sel_hi:[1,0]
    v_pk_mul_f32 v[40:41], v[40:41], v[86:87] op_sel:[0,0] op_sel_hi:[1,0]
    v_pk_fma_f32 v[38:39], v[42:43], v[86:87], v[38:39] op_sel:[0,1,0] op_sel_hi:[1,1,1]
    v_pk_fma_f32 v[40:41], v[44:45], v[86:87], v[40:41] op_sel:[0,1,0] op_sel_hi:[1,1,1]
    v_pk_fma_f32 v[38:39], v[46:47], v[88:89], v[38:39] op_sel:[0,0,0] op_sel_hi:[1,0,1]
    v_pk_fma_f32 v[40:41], v[48:49], v[88:89], v[40:41] op_sel:[0,0,0] op_sel_hi:[1,0,1]
    v_pk_mul_f32 v[38:39], v[38:39], v[50:51]
    v_pk_mul_f32 v[40:41], v[40:41], v[52:53]
    v_cmpx_ne_u32 vcc, v26, v84
    v_cvt_f64_f32 v[46:47], v38
    ds_add_f64 v93, v[46:47] offset:2048
    v_cvt_f64_f32 v[48:49], v39
    ds_add_f64 v90, v[48:49] offset:2048
    v_cvt_f64_f32 v[50:51], v40
    ds_add_f64 v91, v[50:51] offset:2048
    v_cvt_f64_f32 v[52:53], v41
    ds_add_f64 v92, v[52:53] offset:2048
    s_mov_b64 exec, -1
    v_lshrrev_b32 v119, 3, v14
    v_bitop3_b32 v121, v119, v112, v111 bitop3:0xea
    v_and_b32 v94, -9, v121
    ds_read_b128 v[54:57], v94 offset:42240
    s_waitcnt lgkmcnt(0)
acc_gf2:
acc_drain:
    s_cmp_eq_u32 s35, s36
    s_cbranch_scc1 acc_nodrain
    s_call_b64 s[46:47], acc_gen
    v_lshrrev_b32 v119, 3, v14
    v_bitop3_b32 v121, v119, v112, v111 bitop3:0xea
    v_and_b32 v94, -9, v121
    ds_read_b128 v[54:57], v94 offset:42240
    s_waitcnt lgkmcnt(0)
    s_branch acc_drain
acc_nodrain:
    s_setprio 0
    s_waitcnt vmcnt(3) lgkmcnt(4)
    v_mfma_f32_4x4x4_16b_bf16 v[38:41], v[58:59], v[54:55], 0
    v_mfma_f32_4x4x4_16b_bf16 v[42:45], v[62:63], v[54:55], 0
    v_mfma_f32_4x4x4_16b_bf16 v[46:49], v[66:67], v[54:55], 0
    v_mfma_f32_4x4x4_16b_bf16 v[50:53], v[70:71], v[72:73], 0
    v_mfma_f32_4x4x4_16b_bf16 v[38:41], v[60:61], v[56:57], v[38:41]
    v_mfma_f32_4x4x4_16b_bf16 v[42:45], v[64:65], v[56:57], v[42:45]
    v_mfma_f32_4x4x4_16b_bf16 v[46:49], v[68:69], v[56:57], v[46:49]
    v_lshrrev_b32 v120, 3, v15
    v_bitop3_b32 v122, v120, v112, v111 bitop3:0xea
    v_and_b32 v94, -9, v122
    ds_read_b128 v[54:57], v94 offset:42240
    v_cmpx_ne_u32 vcc, v14, v84
    v_and_b32 v86, 0x1fff0000, v119
    v_mul_f32 v86, 0x7622f983, v86
    v_fract_f32 v86, v86
    v_cos_f32 v86, v86
    v_xor_b32 v90, 8, v121
    v_xor_b32 v91, 16, v121
    v_xor_b32 v92, 24, v121
    v_add_f32 v88, v86, v86
    v_fma_f32 v87, v88, v86, -1.0
    v_fma_f32 v88, v88, v87, -v86
    v_pk_mul_f32 v[38:39], v[38:39], v[86:87] op_sel:[0,0] op_sel_hi:[1,0]
    v_pk_mul_f32 v[40:41], v[40:41], v[86:87] op_sel:[0,0] op_sel_hi:[1,0]
    v_pk_fma_f32 v[38:39], v[42:43], v[86:87], v[38:39] op_sel:[0,1,0] op_sel_hi:[1,1,1]
    v_pk_fma_f32 v[40:41], v[44:45], v[86:87], v[40:41] op_sel:[0,1,0] op_sel_hi:[1,1,1]
    v_pk_fma_f32 v[38:39], v[46:47], v[88:89], v[38:39] op_sel:[0,0,0] op_sel_hi:[1,0,1]
    v_pk_fma_f32 v[40:41], v[48:49], v[88:89], v[40:41] op_sel:[0,0,0] op_sel_hi:[1,0,1]
    v_pk_mul_f32 v[38:39], v[38:39], v[50:51]
    v_pk_mul_f32 v[40:41], v[40:41], v[52:53]
    v_cvt_f64_f32 v[46:47], v38
    ds_add_f64 v121, v[46:47] offset:2048
    v_cvt_f64_f32 v[48:49], v39
    ds_add_f64 v90, v[48:49] offset:2048
    v_cvt_f64_f32 v[50:51], v40
    ds_add_f64 v91, v[50:51] offset:2048
    v_cvt_f64_f32 v[52:53], v41
    ds_add_f64 v92, v[52:53] offset:2048
    s_mov_b64 exec, -1
    s_waitcnt vmcnt(2) lgkmcnt(4)
    v_mfma_f32_4x4x4_16b_bf16 v[38:41], v[58:59], v[54:55], 0
    v_mfma_f32_4x4x4_16b_bf16 v[42:45], v[62:63], v[54:55], 0
    v_mfma_f32_4x4x4_16b_bf16 v[46:49], v[66:67], v[54:55], 0
    v_mfma_f32_4x4x4_16b_bf16 v[50:53], v[70:71], v[74:75], 0
    v_mfma_f32_4x4x4_16b_bf16 v[38:41], v[60:61], v[56:57], v[38:41]
    v_mfma_f32_4x4x4_16b_bf16 v[42:45], v[64:65], v[56:57], v[42:45]
    v_mfma_f32_4x4x4_16b_bf16 v[46:49], v[68:69], v[56:57], v[46:49]
    v_lshrrev_b32 v119, 3, v16
    v_bitop3_b32 v121, v119, v112, v111 bitop3:0xea
    v_and_b32 v94, -9, v121
    ds_read_b128 v[54:57], v94 offset:42240
    v_cmpx_ne_u32 vcc, v15, v84
    v_and_b32 v86, 0x1fff0000, v120
    v_mul_f32 v86, 0x7622f983, v86
    v_fract_f32 v86, v86
    v_cos_f32 v86, v86
    v_xor_b32 v90, 8, v122
    v_xor_b32 v91, 16, v122
    v_xor_b32 v92, 24, v122
    v_add_f32 v88, v86, v86
    v_fma_f32 v87, v88, v86, -1.0
    v_fma_f32 v88, v88, v87, -v86
    v_pk_mul_f32 v[38:39], v[38:39], v[86:87] op_sel:[0,0] op_sel_hi:[1,0]
    v_pk_mul_f32 v[40:41], v[40:41], v[86:87] op_sel:[0,0] op_sel_hi:[1,0]
    v_pk_fma_f32 v[38:39], v[42:43], v[86:87], v[38:39] op_sel:[0,1,0] op_sel_hi:[1,1,1]
    v_pk_fma_f32 v[40:41], v[44:45], v[86:87], v[40:41] op_sel:[0,1,0] op_sel_hi:[1,1,1]
    v_pk_fma_f32 v[38:39], v[46:47], v[88:89], v[38:39] op_sel:[0,0,0] op_sel_hi:[1,0,1]
    v_pk_fma_f32 v[40:41], v[48:49], v[88:89], v[40:41] op_sel:[0,0,0] op_sel_hi:[1,0,1]
    v_pk_mul_f32 v[38:39], v[38:39], v[50:51]
    v_pk_mul_f32 v[40:41], v[40:41], v[52:53]
    v_cvt_f64_f32 v[46:47], v38
    ds_add_f64 v122, v[46:47] offset:2048
    v_cvt_f64_f32 v[48:49], v39
    ds_add_f64 v90, v[48:49] offset:2048
    v_cvt_f64_f32 v[50:51], v40
    ds_add_f64 v91, v[50:51] offset:2048
    v_cvt_f64_f32 v[52:53], v41
    ds_add_f64 v92, v[52:53] offset:2048
    s_mov_b64 exec, -1
    s_waitcnt vmcnt(1) lgkmcnt(4)
    v_mfma_f32_4x4x4_16b_bf16 v[38:41], v[58:59], v[54:55], 0
    v_mfma_f32_4x4x4_16b_bf16 v[42:45], v[62:63], v[54:55], 0
    v_mfma_f32_4x4x4_16b_bf16 v[46:49], v[66:67], v[54:55], 0
    v_mfma_f32_4x4x4_16b_bf16 v[50:53], v[70:71], v[76:77], 0
    v_mfma_f32_4x4x4_16b_bf16 v[38:41], v[60:61], v[56:57], v[38:41]
    v_mfma_f32_4x4x4_16b_bf16 v[42:45], v[64:65], v[56:57], v[42:45]
    v_mfma_f32_4x4x4_16b_bf16 v[46:49], v[68:69], v[56:57], v[46:49]
    v_lshrrev_b32 v120, 3, v17
    v_bitop3_b32 v122, v120, v112, v111 bitop3:0xea
    v_and_b32 v94, -9, v122
    ds_read_b128 v[54:57], v94 offset:42240
    v_cmpx_ne_u32 vcc, v16, v84
    v_and_b32 v86, 0x1fff0000, v119
    v_mul_f32 v86, 0x7622f983, v86
    v_fract_f32 v86, v86
    v_cos_f32 v86, v86
    v_xor_b32 v90, 8, v121
    v_xor_b32 v91, 16, v121
    v_xor_b32 v92, 24, v121
    v_add_f32 v88, v86, v86
    v_fma_f32 v87, v88, v86, -1.0
    v_fma_f32 v88, v88, v87, -v86
    v_pk_mul_f32 v[38:39], v[38:39], v[86:87] op_sel:[0,0] op_sel_hi:[1,0]
    v_pk_mul_f32 v[40:41], v[40:41], v[86:87] op_sel:[0,0] op_sel_hi:[1,0]
    v_pk_fma_f32 v[38:39], v[42:43], v[86:87], v[38:39] op_sel:[0,1,0] op_sel_hi:[1,1,1]
    v_pk_fma_f32 v[40:41], v[44:45], v[86:87], v[40:41] op_sel:[0,1,0] op_sel_hi:[1,1,1]
    v_pk_fma_f32 v[38:39], v[46:47], v[88:89], v[38:39] op_sel:[0,0,0] op_sel_hi:[1,0,1]
    v_pk_fma_f32 v[40:41], v[48:49], v[88:89], v[40:41] op_sel:[0,0,0] op_sel_hi:[1,0,1]
    v_pk_mul_f32 v[38:39], v[38:39], v[50:51]
    v_pk_mul_f32 v[40:41], v[40:41], v[52:53]
    v_cvt_f64_f32 v[46:47], v38
    ds_add_f64 v121, v[46:47] offset:2048
    v_cvt_f64_f32 v[48:49], v39
    ds_add_f64 v90, v[48:49] offset:2048
    v_cvt_f64_f32 v[50:51], v40
    ds_add_f64 v91, v[50:51] offset:2048
    v_cvt_f64_f32 v[52:53], v41
    ds_add_f64 v92, v[52:53] offset:2048
    s_mov_b64 exec, -1
    s_waitcnt vmcnt(0) lgkmcnt(4)
    v_mfma_f32_4x4x4_16b_bf16 v[38:41], v[58:59], v[54:55], 0
    v_mfma_f32_4x4x4_16b_bf16 v[42:45], v[62:63], v[54:55], 0
    v_mfma_f32_4x4x4_16b_bf16 v[46:49], v[66:67], v[54:55], 0
    v_mfma_f32_4x4x4_16b_bf16 v[50:53], v[70:71], v[78:79], 0
    v_mfma_f32_4x4x4_16b_bf16 v[38:41], v[60:61], v[56:57], v[38:41]
    v_mfma_f32_4x4x4_16b_bf16 v[42:45], v[64:65], v[56:57], v[42:45]
    v_mfma_f32_4x4x4_16b_bf16 v[46:49], v[68:69], v[56:57], v[46:49]
    v_cmpx_ne_u32 vcc, v17, v84
    v_and_b32 v86, 0x1fff0000, v120
    v_mul_f32 v86, 0x7622f983, v86
    v_fract_f32 v86, v86
    v_cos_f32 v86, v86
    v_xor_b32 v90, 8, v122
    v_xor_b32 v91, 16, v122
    v_xor_b32 v92, 24, v122
    v_add_f32 v88, v86, v86
    v_fma_f32 v87, v88, v86, -1.0
    v_fma_f32 v88, v88, v87, -v86
    v_pk_mul_f32 v[38:39], v[38:39], v[86:87] op_sel:[0,0] op_sel_hi:[1,0]
    v_pk_mul_f32 v[40:41], v[40:41], v[86:87] op_sel:[0,0] op_sel_hi:[1,0]
    v_pk_fma_f32 v[38:39], v[42:43], v[86:87], v[38:39] op_sel:[0,1,0] op_sel_hi:[1,1,1]
    v_pk_fma_f32 v[40:41], v[44:45], v[86:87], v[40:41] op_sel:[0,1,0] op_sel_hi:[1,1,1]
    v_pk_fma_f32 v[38:39], v[46:47], v[88:89], v[38:39] op_sel:[0,0,0] op_sel_hi:[1,0,1]
    v_pk_fma_f32 v[40:41], v[48:49], v[88:89], v[40:41] op_sel:[0,0,0] op_sel_hi:[1,0,1]
    v_pk_mul_f32 v[38:39], v[38:39], v[50:51]
    v_pk_mul_f32 v[40:41], v[40:41], v[52:53]
    v_cvt_f64_f32 v[46:47], v38
    ds_add_f64 v122, v[46:47] offset:2048
    v_cvt_f64_f32 v[48:49], v39
    ds_add_f64 v90, v[48:49] offset:2048
    v_cvt_f64_f32 v[50:51], v40
    ds_add_f64 v91, v[50:51] offset:2048
    v_cvt_f64_f32 v[52:53], v41
    ds_add_f64 v92, v[52:53] offset:2048
    s_mov_b64 exec, -1
    v_lshlrev_b32 v86, 6, v0
    s_waitcnt lgkmcnt(0)
    s_barrier
    s_cmp_ge_u32 s33, 10
    s_cbranch_scc1 acc_done
    ds_read_b128 v[38:41], v86 offset:2048
    ds_read_b128 v[42:45], v86 offset:2064
    ds_read_b128 v[46:49], v86 offset:2080
    ds_read_b128 v[50:53], v86 offset:2096
    s_waitcnt lgkmcnt(2)
    v_cvt_f32_f64 v2, v[38:39]
    v_cvt_f32_f64 v3, v[40:41]
    v_cvt_f32_f64 v4, v[42:43]
    v_cvt_f32_f64 v5, v[44:45]
    v_mul_f32 v10, s72, v2
    v_mul_f32 v11, s73, v2
    v_mul_f32 v12, s74, v2
    v_mul_f32 v13, s75, v2
    v_fmac_f32 v10, s76, v3
    v_fmac_f32 v11, s77, v3
    v_fmac_f32 v12, s78, v3
    v_fmac_f32 v13, s79, v3
    v_fmac_f32 v10, s80, v4
    v_fmac_f32 v11, s81, v4
    v_fmac_f32 v12, s82, v4
    v_fmac_f32 v13, s83, v4
    v_fmac_f32 v10, s84, v5
    v_fmac_f32 v11, s85, v5
    v_fmac_f32 v12, s86, v5
    v_fmac_f32 v13, s87, v5
    s_waitcnt lgkmcnt(0)
    v_cvt_f32_f64 v6, v[46:47]
    v_cvt_f32_f64 v7, v[48:49]
    v_cvt_f32_f64 v8, v[50:51]
    v_cvt_f32_f64 v9, v[52:53]
    v_mul_f32 v14, s72, v6
    v_mul_f32 v15, s73, v6
    v_mul_f32 v16, s74, v6
    v_mul_f32 v17, s75, v6
    v_fmac_f32 v14, s76, v7
    v_fmac_f32 v15, s77, v7
    v_fmac_f32 v16, s78, v7
    v_fmac_f32 v17, s79, v7
    v_fmac_f32 v14, s80, v8
    v_fmac_f32 v15, s81, v8
    v_fmac_f32 v16, s82, v8
    v_fmac_f32 v17, s83, v8
    v_fmac_f32 v14, s84, v9
    v_fmac_f32 v15, s85, v9
    v_fmac_f32 v16, s86, v9
    v_fmac_f32 v17, s87, v9
    v_fmac_f32 v30, v10, v98
    v_fmac_f32 v31, v11, v99
    v_fmac_f32 v32, v12, v100
    v_fmac_f32 v33, v13, v101
    v_fmac_f32 v34, v14, v102
    v_fmac_f32 v35, v15, v103
    v_fmac_f32 v36, v16, v104
    v_fmac_f32 v37, v17, v105
    v_cvt_pk_bf16_f32 v38, v30, v31
    v_cvt_pk_bf16_f32 v39, v32, v33
    v_cvt_pk_bf16_f32 v40, v34, v35
    v_cvt_pk_bf16_f32 v41, v36, v37
    buffer_store_dwordx4 v[38:41], v18, s[24:27], 0 offen
acc_done:
    s_endpgm
acc_fill4:
    v_and_b32 v123, 0xffc, v37
    s_mov_b64 exec, s[74:75]
    ds_add_rtn_u32 v125, v123, v114 offset:384
    s_mov_b64 exec, -1
    s_waitcnt lgkmcnt(0)
    v_mad_u32_u24 v96, v123, 34, v125
    s_mov_b64 exec, s[74:75]
    v_cmp_le_i32 vcc, s34, v125
    s_cbranch_vccnz acc_fs42o
    ds_write_b32 v96, v34
    s_mov_b64 exec, -1
acc_fs42:
    v_lshrrev_b32 v123, 10, v37
    v_and_b32 v123, 0xffc, v123
    s_mov_b64 exec, s[74:75]
    ds_add_rtn_u32 v125, v123, v114 offset:384
    s_mov_b64 exec, -1
    s_waitcnt lgkmcnt(0)
    v_mad_u32_u24 v96, v123, 34, v125
    s_mov_b64 exec, s[74:75]
    v_cmp_le_i32 vcc, s34, v125
    s_cbranch_vccnz acc_fs43o
    ds_write_b32 v96, v35
    s_mov_b64 exec, -1
acc_fs43:
    v_lshrrev_b32 v123, 20, v37
    v_and_b32 v123, 0xffc, v123
    s_mov_b64 exec, s[74:75]
    ds_add_rtn_u32 v125, v123, v114 offset:384
    s_mov_b64 exec, -1
    s_waitcnt lgkmcnt(0)
    v_mad_u32_u24 v96, v123, 34, v125
    s_mov_b64 exec, s[74:75]
    v_cmp_le_i32 vcc, s34, v125
    s_cbranch_vccnz acc_fs44o
    ds_write_b32 v96, v36
    s_mov_b64 exec, -1
acc_fs44:
    s_setpc_b64 s[44:45]
acc_build:
    s_cmp_le_u32 s35, s6
    s_cbranch_scc1 acc_build1
    s_call_b64 s[46:47], acc_gen0
    s_branch acc_build
acc_build1:
    v_and_b32 v86, 0xffff, v126
    v_and_b32 v109, 0xffff, v126
    v_lshrrev_b32 v108, 16, v126
    v_add_u32_dpp v86, v86, v86 row_shr:1 row_mask:0xf bank_mask:0xf
    v_mov_b32 v38, -256
    v_lshl_add_u32 v91, v115, 2, s6
    v_add_u32_dpp v86, v86, v86 row_shr:2 row_mask:0xf bank_mask:0xf
    ds_write2st64_b32 v91, v38, v38 offset0:0 offset1:1
    ds_write2st64_b32 v91, v38, v38 offset0:2 offset1:3
    v_add_u32_dpp v86, v86, v86 row_shr:4 row_mask:0xf bank_mask:0xf
    ds_write_b32 v91, v38 offset:1024
    v_lshl_add_u32 v108, v108, 4, v110
    v_add_u32_dpp v86, v86, v86 row_shr:8 row_mask:0xf bank_mask:0xf
    v_lshrrev_b32 v92, 5, v115
    v_lshrrev_b32 v90, 5, v115
    v_add_u32_dpp v86, v86, v86 row_bcast:15 row_mask:0xa bank_mask:0xf
    v_lshl_add_u32 v89, v92, 4, v108
    v_readlane_b32 s38, v86, 31
    v_sub_u32 v86, v86, v109
    v_sub_u32 v87, 320, v86
    v_med3_i32 v87, v87, 0, v109
    v_add_u32 v88, v86, v92
    v_lshl_add_u32 v88, v88, 2, s6
    v_cmpx_lt_u32 vcc, v90, v87
acc_bl:
    ds_write_b32 v88, v89
    v_add_u32 v90, 2, v90
    v_add_u32 v88, 8, v88
    v_add_u32 v89, 32, v89
    v_cmpx_lt_u32 vcc, v90, v87
    s_cbranch_execnz acc_bl
    s_mov_b64 exec, -1
    ds_read2st64_b32 v[38:39], v91 offset0:0 offset1:1
    ds_read2st64_b32 v[40:41], v91 offset0:2 offset1:3
    ds_read_b32 v42, v91 offset:1024
    s_cmp_le_u32 s38, 320
    s_cbranch_scc1 acc_bret
    s_mov_b32 s43, 1
    s_cmp_eq_u32 s42, 0
    s_cbranch_scc1 acc_bret
    s_sub_u32 s42, s42, 1
    v_add_u32 v87, v87, v92
    v_lshl_add_u32 v108, v87, 4, v108
    v_sub_u32 v109, v109, v87
acc_ll:
    v_cmp_lt_i32 vcc, 0, v109
    s_cbranch_vccz acc_bret
    v_mov_b32 v86, -256
    s_nop 0
    v_cndmask_b32_e64 v86, v86, v108, vcc
    buffer_load_dwordx4 v[2:5], v86, s[16:19], 0 offen
    v_add_u32 v108, 32, v108
    v_subrev_u32 v109, 2, v109
    s_waitcnt vmcnt(0)
    v_and_b32 v97, 0xffc, v5
    v_cmp_gt_u32 vcc, 64, v97
    v_max_u32 v97, 64, v97
    v_add_u32 v97, s42, v97
    v_cndmask_b32_e64 v96, v2, v84, vcc
    s_call_b64 s[46:47], acc_gen2
    v_lshrrev_b32 v97, 10, v5
    v_and_b32 v97, 0xffc, v97
    v_cmp_gt_u32 vcc, 64, v97
    v_max_u32 v97, 64, v97
    v_add_u32 v97, s42, v97
    v_cndmask_b32_e64 v96, v3, v84, vcc
    s_call_b64 s[46:47], acc_gen2
    v_lshrrev_b32 v97, 20, v5
    v_and_b32 v97, 0xffc, v97
    v_cmp_gt_u32 vcc, 64, v97
    v_max_u32 v97, 64, v97
    v_add_u32 v97, s42, v97
    v_cndmask_b32_e64 v96, v4, v84, vcc
    s_call_b64 s[46:47], acc_gen2
    s_branch acc_ll
acc_bret:
    s_waitcnt lgkmcnt(0)
    s_setpc_b64 s[44:45]
acc_gen0:
    ds_read_b32 v118, v111 offset:0
    s_waitcnt lgkmcnt(0)
    v_readfirstlane_b32 s41, v118
    s_cmp_ge_u32 s41, 64
    s_cbranch_scc0 acc_ck45a
acc_ck45b:
    v_mov_b32 v118, 0
acc_gen:
    s_sub_u32 s41, s35, s36
    s_min_u32 s41, s41, 512
    s_sub_u32 s35, s35, s41
    v_mov_b32 v96, v84
    v_mov_b32 v97, 0x7ffffff0
    v_lshlrev_b32 v89, 3, v115
    v_add_u32 v93, s35, v89
    v_cmpx_gt_u32 vcc, s41, v89
    ds_read_b64 v[96:97], v93
    s_mov_b64 exec, -1
    s_waitcnt lgkmcnt(0)
acc_gen2:
    v_lshrrev_b32 v89, 4, v97
    v_subrev_u32 v89, 4, v89
    v_min_u32 v89, 0x1000, v89
    v_mul_u32_u24 v89, 834, v89
    v_and_b32 v93, 0x3ff, v96
    v_add_lshl_u32 v89, v89, v93, 3
    buffer_load_dwordx2 v[94:95], v89, s[12:15], 0 offen
    v_lshrrev_b32 v89, 3, v96
    v_and_b32 v93, 0xff80, v89
    v_and_b32 v97, 12, v97
    v_lshl_add_u32 v93, v97, 3, v93
    ds_read_b128 v[54:57], v93 offset:42240
    v_and_or_b32 v93, v111, 24, v93
    s_waitcnt vmcnt(0) lgkmcnt(0)
    v_mfma_f32_4x4x4_16b_bf16 v[38:41], v[58:59], v[54:55], 0
    v_mfma_f32_4x4x4_16b_bf16 v[42:45], v[62:63], v[54:55], 0
    v_mfma_f32_4x4x4_16b_bf16 v[46:49], v[66:67], v[54:55], 0
    v_mfma_f32_4x4x4_16b_bf16 v[50:53], v[70:71], v[94:95], 0
    v_mfma_f32_4x4x4_16b_bf16 v[38:41], v[60:61], v[56:57], v[38:41]
    v_mfma_f32_4x4x4_16b_bf16 v[42:45], v[64:65], v[56:57], v[42:45]
    v_mfma_f32_4x4x4_16b_bf16 v[46:49], v[68:69], v[56:57], v[46:49]
    v_and_b32 v86, 0x1fff0000, v89
    v_mul_f32 v86, 0x7622f983, v86
    v_fract_f32 v86, v86
    v_cos_f32 v86, v86
    v_xor_b32 v90, 8, v93
    v_xor_b32 v91, 16, v93
    v_xor_b32 v92, 24, v93
    v_add_f32 v88, v86, v86
    v_fma_f32 v87, v88, v86, -1.0
    v_fma_f32 v88, v88, v87, -v86
    v_pk_mul_f32 v[38:39], v[38:39], v[86:87] op_sel:[0,0] op_sel_hi:[1,0]
    v_pk_mul_f32 v[40:41], v[40:41], v[86:87] op_sel:[0,0] op_sel_hi:[1,0]
    v_pk_fma_f32 v[38:39], v[42:43], v[86:87], v[38:39] op_sel:[0,1,0] op_sel_hi:[1,1,1]
    v_pk_fma_f32 v[40:41], v[44:45], v[86:87], v[40:41] op_sel:[0,1,0] op_sel_hi:[1,1,1]
    v_pk_fma_f32 v[38:39], v[46:47], v[88:89], v[38:39] op_sel:[0,0,0] op_sel_hi:[1,0,1]
    v_pk_fma_f32 v[40:41], v[48:49], v[88:89], v[40:41] op_sel:[0,0,0] op_sel_hi:[1,0,1]
    v_pk_mul_f32 v[38:39], v[38:39], v[50:51]
    v_pk_mul_f32 v[40:41], v[40:41], v[52:53]
    v_cmpx_ne_u32 vcc, v96, v84
    v_cvt_f64_f32 v[46:47], v38
    ds_add_f64 v93, v[46:47] offset:2048
    v_cvt_f64_f32 v[48:49], v39
    ds_add_f64 v90, v[48:49] offset:2048
    v_cvt_f64_f32 v[50:51], v40
    ds_add_f64 v91, v[50:51] offset:2048
    v_cvt_f64_f32 v[52:53], v41
    ds_add_f64 v92, v[52:53] offset:2048
    s_mov_b64 exec, -1
    s_setpc_b64 s[46:47]
acc_fs1o:
    s_andn2_b64 exec, exec, vcc
    ds_write_b32 v96, v18
    s_mov_b64 exec, vcc
    v_mbcnt_lo_u32_b32 v97, vcc_lo, 0
    v_mbcnt_hi_u32_b32 v97, vcc_hi, v97
    v_add_u32 v123, s4, v123
    v_lshl_add_u32 v97, v97, 3, s35
    ds_write2_b32 v97, v18, v123 offset0:0 offset1:1
    s_bcnt1_i32_b64 s41, vcc
    s_lshl3_add_u32 s35, s41, s35
    s_mov_b64 exec, -1
    s_cmp_ge_u32 s35, s37
    s_cbranch_scc0 acc_fs1
    s_call_b64 s[46:47], acc_gen0
    s_branch acc_fs1
acc_fs2o:
    s_andn2_b64 exec, exec, vcc
    ds_write_b32 v96, v19
    s_mov_b64 exec, vcc
    v_mbcnt_lo_u32_b32 v97, vcc_lo, 0
    v_mbcnt_hi_u32_b32 v97, vcc_hi, v97
    v_add_u32 v123, s4, v123
    v_lshl_add_u32 v97, v97, 3, s35
    ds_write2_b32 v97, v19, v123 offset0:0 offset1:1
    s_bcnt1_i32_b64 s41, vcc
    s_lshl3_add_u32 s35, s41, s35
    s_mov_b64 exec, -1
    s_cmp_ge_u32 s35, s37
    s_cbranch_scc0 acc_fs2
    s_call_b64 s[46:47], acc_gen0
    s_branch acc_fs2
acc_fs3o:
    s_andn2_b64 exec, exec, vcc
    ds_write_b32 v96, v20
    s_mov_b64 exec, vcc
    v_mbcnt_lo_u32_b32 v97, vcc_lo, 0
    v_mbcnt_hi_u32_b32 v97, vcc_hi, v97
    v_add_u32 v123, s4, v123
    v_lshl_add_u32 v97, v97, 3, s35
    ds_write2_b32 v97, v20, v123 offset0:0 offset1:1
    s_bcnt1_i32_b64 s41, vcc
    s_lshl3_add_u32 s35, s41, s35
    s_mov_b64 exec, -1
    s_cmp_ge_u32 s35, s37
    s_cbranch_scc0 acc_fs3
    s_call_b64 s[46:47], acc_gen0
    s_branch acc_fs3
acc_fs4o:
    s_andn2_b64 exec, exec, vcc
    ds_write_b32 v96, v22
    s_mov_b64 exec, vcc
    v_mbcnt_lo_u32_b32 v97, vcc_lo, 0
    v_mbcnt_hi_u32_b32 v97, vcc_hi, v97
    v_add_u32 v123, s4, v123
    v_lshl_add_u32 v97, v97, 3, s35
    ds_write2_b32 v97, v22, v123 offset0:0 offset1:1
    s_bcnt1_i32_b64 s41, vcc
    s_lshl3_add_u32 s35, s41, s35
    s_mov_b64 exec, -1
    s_cmp_ge_u32 s35, s37
    s_cbranch_scc0 acc_fs4
    s_call_b64 s[46:47], acc_gen0
    s_branch acc_fs4
acc_fs5o:
    s_andn2_b64 exec, exec, vcc
    ds_write_b32 v96, v23
    s_mov_b64 exec, vcc
    v_mbcnt_lo_u32_b32 v97, vcc_lo, 0
    v_mbcnt_hi_u32_b32 v97, vcc_hi, v97
    v_add_u32 v123, s4, v123
    v_lshl_add_u32 v97, v97, 3, s35
    ds_write2_b32 v97, v23, v123 offset0:0 offset1:1
    s_bcnt1_i32_b64 s41, vcc
    s_lshl3_add_u32 s35, s41, s35
    s_mov_b64 exec, -1
    s_cmp_ge_u32 s35, s37
    s_cbranch_scc0 acc_fs5
    s_call_b64 s[46:47], acc_gen0
    s_branch acc_fs5
acc_fs6o:
    s_andn2_b64 exec, exec, vcc
    ds_write_b32 v96, v24
    s_mov_b64 exec, vcc
    v_mbcnt_lo_u32_b32 v97, vcc_lo, 0
    v_mbcnt_hi_u32_b32 v97, vcc_hi, v97
    v_add_u32 v123, s4, v123
    v_lshl_add_u32 v97, v97, 3, s35
    ds_write2_b32 v97, v24, v123 offset0:0 offset1:1
    s_bcnt1_i32_b64 s41, vcc
    s_lshl3_add_u32 s35, s41, s35
    s_mov_b64 exec, -1
    s_cmp_ge_u32 s35, s37
    s_cbranch_scc0 acc_fs6
    s_call_b64 s[46:47], acc_gen0
    s_branch acc_fs6
acc_fs7o:
    s_andn2_b64 exec, exec, vcc
    ds_write_b32 v96, v26
    s_mov_b64 exec, vcc
    v_mbcnt_lo_u32_b32 v97, vcc_lo, 0
    v_mbcnt_hi_u32_b32 v97, vcc_hi, v97
    v_add_u32 v123, s4, v123
    v_lshl_add_u32 v97, v97, 3, s35
    ds_write2_b32 v97, v26, v123 offset0:0 offset1:1
    s_bcnt1_i32_b64 s41, vcc
    s_lshl3_add_u32 s35, s41, s35
    s_mov_b64 exec, -1
    s_cmp_ge_u32 s35, s37
    s_cbranch_scc0 acc_fs7
    s_call_b64 s[46:47], acc_gen0
    s_branch acc_fs7
acc_fs8o:
    s_andn2_b64 exec, exec, vcc
    ds_write_b32 v96, v27
    s_mov_b64 exec, vcc
    v_mbcnt_lo_u32_b32 v97, vcc_lo, 0
    v_mbcnt_hi_u32_b32 v97, vcc_hi, v97
    v_add_u32 v123, s4, v123
    v_lshl_add_u32 v97, v97, 3, s35
    ds_write2_b32 v97, v27, v123 offset0:0 offset1:1
    s_bcnt1_i32_b64 s41, vcc
    s_lshl3_add_u32 s35, s41, s35
    s_mov_b64 exec, -1
    s_cmp_ge_u32 s35, s37
    s_cbranch_scc0 acc_fs8
    s_call_b64 s[46:47], acc_gen0
    s_branch acc_fs8
acc_fs9o:
    s_andn2_b64 exec, exec, vcc
    ds_write_b32 v96, v28
    s_mov_b64 exec, vcc
    v_mbcnt_lo_u32_b32 v97, vcc_lo, 0
    v_mbcnt_hi_u32_b32 v97, vcc_hi, v97
    v_add_u32 v123, s4, v123
    v_lshl_add_u32 v97, v97, 3, s35
    ds_write2_b32 v97, v28, v123 offset0:0 offset1:1
    s_bcnt1_i32_b64 s41, vcc
    s_lshl3_add_u32 s35, s41, s35
    s_mov_b64 exec, -1
    s_cmp_ge_u32 s35, s37
    s_cbranch_scc0 acc_fs9
    s_call_b64 s[46:47], acc_gen0
    s_branch acc_fs9
acc_fs10o:
    s_andn2_b64 exec, exec, vcc
    ds_write_b32 v96, v30
    s_mov_b64 exec, vcc
    v_mbcnt_lo_u32_b32 v97, vcc_lo, 0
    v_mbcnt_hi_u32_b32 v97, vcc_hi, v97
    v_add_u32 v123, s4, v123
    v_lshl_add_u32 v97, v97, 3, s35
    ds_write2_b32 v97, v30, v123 offset0:0 offset1:1
    s_bcnt1_i32_b64 s41, vcc
    s_lshl3_add_u32 s35, s41, s35
    s_mov_b64 exec, -1
    s_cmp_ge_u32 s35, s37
    s_cbranch_scc0 acc_fs10
    s_call_b64 s[46:47], acc_gen0
    s_branch acc_fs10
acc_fs11o:
    s_andn2_b64 exec, exec, vcc
    ds_write_b32 v96, v31
    s_mov_b64 exec, vcc
    v_mbcnt_lo_u32_b32 v97, vcc_lo, 0
    v_mbcnt_hi_u32_b32 v97, vcc_hi, v97
    v_add_u32 v123, s4, v123
    v_lshl_add_u32 v97, v97, 3, s35
    ds_write2_b32 v97, v31, v123 offset0:0 offset1:1
    s_bcnt1_i32_b64 s41, vcc
    s_lshl3_add_u32 s35, s41, s35
    s_mov_b64 exec, -1
    s_cmp_ge_u32 s35, s37
    s_cbranch_scc0 acc_fs11
    s_call_b64 s[46:47], acc_gen0
    s_branch acc_fs11
acc_fs12o:
    s_andn2_b64 exec, exec, vcc
    ds_write_b32 v96, v32
    s_mov_b64 exec, vcc
    v_mbcnt_lo_u32_b32 v97, vcc_lo, 0
    v_mbcnt_hi_u32_b32 v97, vcc_hi, v97
    v_add_u32 v123, s4, v123
    v_lshl_add_u32 v97, v97, 3, s35
    ds_write2_b32 v97, v32, v123 offset0:0 offset1:1
    s_bcnt1_i32_b64 s41, vcc
    s_lshl3_add_u32 s35, s41, s35
    s_mov_b64 exec, -1
    s_cmp_ge_u32 s35, s37
    s_cbranch_scc0 acc_fs12
    s_call_b64 s[46:47], acc_gen0
    s_branch acc_fs12
acc_ck13a:
    s_setprio 0
acc_ck13c:
    ds_read_b32 v118, v111 offset:128
    s_waitcnt lgkmcnt(0)
    v_readfirstlane_b32 s41, v118
    s_cmp_ge_u32 s41, s40
    s_cbranch_scc0 acc_ck13c
    s_setprio 0
    s_branch acc_ck13b
acc_ck14a:
    s_setprio 0
acc_ck14c:
    ds_read_b32 v118, v111 offset:256
    s_waitcnt lgkmcnt(0)
    v_readfirstlane_b32 s41, v118
    s_cmp_ge_u32 s41, s40
    s_cbranch_scc0 acc_ck14c
    s_setprio 2
    s_branch acc_ck14b
acc_fs15o:
    s_andn2_b64 exec, exec, vcc
    ds_write_b32 v96, v18
    s_mov_b64 exec, vcc
    v_mbcnt_lo_u32_b32 v97, vcc_lo, 0
    v_mbcnt_hi_u32_b32 v97, vcc_hi, v97
    v_add_u32 v123, s4, v123
    v_lshl_add_u32 v97, v97, 3, s35
    ds_write2_b32 v97, v18, v123 offset0:0 offset1:1
    s_bcnt1_i32_b64 s41, vcc
    s_lshl3_add_u32 s35, s41, s35
    s_mov_b64 exec, -1
    s_cmp_ge_u32 s35, s37
    s_cbranch_scc0 acc_fs15
    s_call_b64 s[46:47], acc_gen
    v_lshrrev_b32 v119, 3, v6
    v_bitop3_b32 v121, v119, v112, v111 bitop3:0xea
    v_and_b32 v94, -9, v121
    ds_read_b128 v[54:57], v94 offset:42240
    s_waitcnt lgkmcnt(0)
    s_branch acc_fs15
acc_fs16o:
    s_andn2_b64 exec, exec, vcc
    ds_write_b32 v96, v19
    s_mov_b64 exec, vcc
    v_mbcnt_lo_u32_b32 v97, vcc_lo, 0
    v_mbcnt_hi_u32_b32 v97, vcc_hi, v97
    v_add_u32 v124, s4, v124
    v_lshl_add_u32 v97, v97, 3, s35
    ds_write2_b32 v97, v19, v124 offset0:0 offset1:1
    s_bcnt1_i32_b64 s41, vcc
    s_lshl3_add_u32 s35, s41, s35
    s_mov_b64 exec, -1
    s_cmp_ge_u32 s35, s37
    s_cbranch_scc0 acc_fs16
    s_call_b64 s[46:47], acc_gen
    v_lshrrev_b32 v119, 3, v6
    v_bitop3_b32 v121, v119, v112, v111 bitop3:0xea
    v_and_b32 v94, -9, v121
    ds_read_b128 v[54:57], v94 offset:42240
    s_waitcnt lgkmcnt(0)
    s_branch acc_fs16
acc_fs17o:
    s_andn2_b64 exec, exec, vcc
    ds_write_b32 v96, v20
    s_mov_b64 exec, vcc
    v_mbcnt_lo_u32_b32 v97, vcc_lo, 0
    v_mbcnt_hi_u32_b32 v97, vcc_hi, v97
    v_add_u32 v123, s4, v123
    v_lshl_add_u32 v97, v97, 3, s35
    ds_write2_b32 v97, v20, v123 offset0:0 offset1:1
    s_bcnt1_i32_b64 s41, vcc
    s_lshl3_add_u32 s35, s41, s35
    s_mov_b64 exec, -1
    s_cmp_ge_u32 s35, s37
    s_cbranch_scc0 acc_fs17
    s_call_b64 s[46:47], acc_gen
    v_lshrrev_b32 v120, 3, v7
    v_bitop3_b32 v122, v120, v112, v111 bitop3:0xea
    v_and_b32 v94, -9, v122
    ds_read_b128 v[54:57], v94 offset:42240
    s_waitcnt lgkmcnt(0)
    s_branch acc_fs17
acc_fs18o:
    s_andn2_b64 exec, exec, vcc
    ds_write_b32 v96, v22
    s_mov_b64 exec, vcc
    v_mbcnt_lo_u32_b32 v97, vcc_lo, 0
    v_mbcnt_hi_u32_b32 v97, vcc_hi, v97
    v_add_u32 v124, s4, v124
    v_lshl_add_u32 v97, v97, 3, s35
    ds_write2_b32 v97, v22, v124 offset0:0 offset1:1
    s_bcnt1_i32_b64 s41, vcc
    s_lshl3_add_u32 s35, s41, s35
    s_mov_b64 exec, -1
    s_cmp_ge_u32 s35, s37
    s_cbranch_scc0 acc_fs18
    s_call_b64 s[46:47], acc_gen
    v_lshrrev_b32 v120, 3, v7
    v_bitop3_b32 v122, v120, v112, v111 bitop3:0xea
    v_and_b32 v94, -9, v122
    ds_read_b128 v[54:57], v94 offset:42240
    s_waitcnt lgkmcnt(0)
    s_branch acc_fs18
acc_fs19o:
    s_andn2_b64 exec, exec, vcc
    ds_write_b32 v96, v23
    s_mov_b64 exec, vcc
    v_mbcnt_lo_u32_b32 v97, vcc_lo, 0
    v_mbcnt_hi_u32_b32 v97, vcc_hi, v97
    v_add_u32 v123, s4, v123
    v_lshl_add_u32 v97, v97, 3, s35
    ds_write2_b32 v97, v23, v123 offset0:0 offset1:1
    s_bcnt1_i32_b64 s41, vcc
    s_lshl3_add_u32 s35, s41, s35
    s_mov_b64 exec, -1
    s_cmp_ge_u32 s35, s37
    s_cbranch_scc0 acc_fs19
    s_call_b64 s[46:47], acc_gen
    v_lshrrev_b32 v119, 3, v8
    v_bitop3_b32 v121, v119, v112, v111 bitop3:0xea
    v_and_b32 v94, -9, v121
    ds_read_b128 v[54:57], v94 offset:42240
    s_waitcnt lgkmcnt(0)
    s_branch acc_fs19
acc_fs20o:
    s_andn2_b64 exec, exec, vcc
    ds_write_b32 v96, v24
    s_mov_b64 exec, vcc
    v_mbcnt_lo_u32_b32 v97, vcc_lo, 0
    v_mbcnt_hi_u32_b32 v97, vcc_hi, v97
    v_add_u32 v124, s4, v124
    v_lshl_add_u32 v97, v97, 3, s35
    ds_write2_b32 v97, v24, v124 offset0:0 offset1:1
    s_bcnt1_i32_b64 s41, vcc
    s_lshl3_add_u32 s35, s41, s35
    s_mov_b64 exec, -1
    s_cmp_ge_u32 s35, s37
    s_cbranch_scc0 acc_fs20
    s_call_b64 s[46:47], acc_gen
    v_lshrrev_b32 v119, 3, v8
    v_bitop3_b32 v121, v119, v112, v111 bitop3:0xea
    v_and_b32 v94, -9, v121
    ds_read_b128 v[54:57], v94 offset:42240
    s_waitcnt lgkmcnt(0)
    s_branch acc_fs20
acc_fs21o:
    s_andn2_b64 exec, exec, vcc
    ds_write_b32 v96, v26
    s_mov_b64 exec, vcc
    v_mbcnt_lo_u32_b32 v97, vcc_lo, 0
    v_mbcnt_hi_u32_b32 v97, vcc_hi, v97
    v_add_u32 v123, s4, v123
    v_lshl_add_u32 v97, v97, 3, s35
    ds_write2_b32 v97, v26, v123 offset0:0 offset1:1
    s_bcnt1_i32_b64 s41, vcc
    s_lshl3_add_u32 s35, s41, s35
    s_mov_b64 exec, -1
    s_cmp_ge_u32 s35, s37
    s_cbranch_scc0 acc_fs21
    s_call_b64 s[46:47], acc_gen
    v_lshrrev_b32 v120, 3, v9
    v_bitop3_b32 v122, v120, v112, v111 bitop3:0xea
    v_and_b32 v94, -9, v122
    ds_read_b128 v[54:57], v94 offset:42240
    s_waitcnt lgkmcnt(0)
    s_branch acc_fs21
acc_fs22o:
    s_andn2_b64 exec, exec, vcc
    ds_write_b32 v96, v27
    s_mov_b64 exec, vcc
    v_mbcnt_lo_u32_b32 v97, vcc_lo, 0
    v_mbcnt_hi_u32_b32 v97, vcc_hi, v97
    v_add_u32 v124, s4, v124
    v_lshl_add_u32 v97, v97, 3, s35
    ds_write2_b32 v97, v27, v124 offset0:0 offset1:1
    s_bcnt1_i32_b64 s41, vcc
    s_lshl3_add_u32 s35, s41, s35
    s_mov_b64 exec, -1
    s_cmp_ge_u32 s35, s37
    s_cbranch_scc0 acc_fs22
    s_call_b64 s[46:47], acc_gen
    v_lshrrev_b32 v120, 3, v9
    v_bitop3_b32 v122, v120, v112, v111 bitop3:0xea
    v_and_b32 v94, -9, v122
    ds_read_b128 v[54:57], v94 offset:42240
    s_waitcnt lgkmcnt(0)
    s_branch acc_fs22
acc_fs23o:
    s_andn2_b64 exec, exec, vcc
    ds_write_b32 v96, v28
    s_mov_b64 exec, vcc
    v_mbcnt_lo_u32_b32 v97, vcc_lo, 0
    v_mbcnt_hi_u32_b32 v97, vcc_hi, v97
    v_add_u32 v123, s4, v123
    v_lshl_add_u32 v97, v97, 3, s35
    ds_write2_b32 v97, v28, v123 offset0:0 offset1:1
    s_bcnt1_i32_b64 s41, vcc
    s_lshl3_add_u32 s35, s41, s35
    s_mov_b64 exec, -1
    s_cmp_ge_u32 s35, s37
    s_cbranch_scc0 acc_fs23
    s_call_b64 s[46:47], acc_gen
    v_lshrrev_b32 v119, 3, v10
    v_bitop3_b32 v121, v119, v112, v111 bitop3:0xea
    v_and_b32 v94, -9, v121
    ds_read_b128 v[54:57], v94 offset:42240
    s_waitcnt lgkmcnt(0)
    s_branch acc_fs23
acc_fs24o:
    s_andn2_b64 exec, exec, vcc
    ds_write_b32 v96, v30
    s_mov_b64 exec, vcc
    v_mbcnt_lo_u32_b32 v97, vcc_lo, 0
    v_mbcnt_hi_u32_b32 v97, vcc_hi, v97
    v_add_u32 v124, s4, v124
    v_lshl_add_u32 v97, v97, 3, s35
    ds_write2_b32 v97, v30, v124 offset0:0 offset1:1
    s_bcnt1_i32_b64 s41, vcc
    s_lshl3_add_u32 s35, s41, s35
    s_mov_b64 exec, -1
    s_cmp_ge_u32 s35, s37
    s_cbranch_scc0 acc_fs24
    s_call_b64 s[46:47], acc_gen
    v_lshrrev_b32 v119, 3, v10
    v_bitop3_b32 v121, v119, v112, v111 bitop3:0xea
    v_and_b32 v94, -9, v121
    ds_read_b128 v[54:57], v94 offset:42240
    s_waitcnt lgkmcnt(0)
    s_branch acc_fs24
acc_fs25o:
    s_andn2_b64 exec, exec, vcc
    ds_write_b32 v96, v31
    s_mov_b64 exec, vcc
    v_mbcnt_lo_u32_b32 v97, vcc_lo, 0
    v_mbcnt_hi_u32_b32 v97, vcc_hi, v97
    v_add_u32 v123, s4, v123
    v_lshl_add_u32 v97, v97, 3, s35
    ds_write2_b32 v97, v31, v123 offset0:0 offset1:1
    s_bcnt1_i32_b64 s41, vcc
    s_lshl3_add_u32 s35, s41, s35
    s_mov_b64 exec, -1
    s_cmp_ge_u32 s35, s37
    s_cbranch_scc0 acc_fs25
    s_call_b64 s[46:47], acc_gen
    v_lshrrev_b32 v120, 3, v11
    v_bitop3_b32 v122, v120, v112, v111 bitop3:0xea
    v_and_b32 v94, -9, v122
    ds_read_b128 v[54:57], v94 offset:42240
    s_waitcnt lgkmcnt(0)
    s_branch acc_fs25
acc_fs26o:
    s_andn2_b64 exec, exec, vcc
    ds_write_b32 v96, v32
    s_mov_b64 exec, vcc
    v_mbcnt_lo_u32_b32 v97, vcc_lo, 0
    v_mbcnt_hi_u32_b32 v97, vcc_hi, v97
    v_add_u32 v124, s4, v124
    v_lshl_add_u32 v97, v97, 3, s35
    ds_write2_b32 v97, v32, v124 offset0:0 offset1:1
    s_bcnt1_i32_b64 s41, vcc
    s_lshl3_add_u32 s35, s41, s35
    s_mov_b64 exec, -1
    s_cmp_ge_u32 s35, s37
    s_cbranch_scc0 acc_fs26
    s_call_b64 s[46:47], acc_gen
    v_lshrrev_b32 v120, 3, v11
    v_bitop3_b32 v122, v120, v112, v111 bitop3:0xea
    v_and_b32 v94, -9, v122
    ds_read_b128 v[54:57], v94 offset:42240
    s_waitcnt lgkmcnt(0)
    s_branch acc_fs26
acc_ck27a:
    s_setprio 0
acc_ck27c:
    ds_read_b32 v118, v111 offset:128
    s_waitcnt lgkmcnt(0)
    v_readfirstlane_b32 s41, v118
    s_cmp_ge_u32 s41, s40
    s_cbranch_scc0 acc_ck27c
    s_setprio 0
    s_branch acc_ck27b
acc_ck28a:
    s_setprio 0
acc_ck28c:
    ds_read_b32 v118, v111 offset:256
    s_waitcnt lgkmcnt(0)
    v_readfirstlane_b32 s41, v118
    s_cmp_ge_u32 s41, s40
    s_cbranch_scc0 acc_ck28c
    s_setprio 1
    s_branch acc_ck28b
acc_fs29o:
    s_andn2_b64 exec, exec, vcc
    ds_write_b32 v96, v18
    s_mov_b64 exec, vcc
    v_mbcnt_lo_u32_b32 v97, vcc_lo, 0
    v_mbcnt_hi_u32_b32 v97, vcc_hi, v97
    v_add_u32 v123, s4, v123
    v_lshl_add_u32 v97, v97, 3, s35
    ds_write2_b32 v97, v18, v123 offset0:0 offset1:1
    s_bcnt1_i32_b64 s41, vcc
    s_lshl3_add_u32 s35, s41, s35
    s_mov_b64 exec, -1
    s_cmp_ge_u32 s35, s37
    s_cbranch_scc0 acc_fs29
    s_call_b64 s[46:47], acc_gen
    v_lshrrev_b32 v119, 3, v6
    v_bitop3_b32 v121, v119, v112, v111 bitop3:0xea
    v_and_b32 v94, -9, v121
    ds_read_b128 v[54:57], v94 offset:42240
    s_waitcnt lgkmcnt(0)
    s_branch acc_fs29
acc_fs30o:
    s_andn2_b64 exec, exec, vcc
    ds_write_b32 v96, v19
    s_mov_b64 exec, vcc
    v_mbcnt_lo_u32_b32 v97, vcc_lo, 0
    v_mbcnt_hi_u32_b32 v97, vcc_hi, v97
    v_add_u32 v124, s4, v124
    v_lshl_add_u32 v97, v97, 3, s35
    ds_write2_b32 v97, v19, v124 offset0:0 offset1:1
    s_bcnt1_i32_b64 s41, vcc
    s_lshl3_add_u32 s35, s41, s35
    s_mov_b64 exec, -1
    s_cmp_ge_u32 s35, s37
    s_cbranch_scc0 acc_fs30
    s_call_b64 s[46:47], acc_gen
    v_lshrrev_b32 v119, 3, v6
    v_bitop3_b32 v121, v119, v112, v111 bitop3:0xea
    v_and_b32 v94, -9, v121
    ds_read_b128 v[54:57], v94 offset:42240
    s_waitcnt lgkmcnt(0)
    s_branch acc_fs30
acc_fs31o:
    s_andn2_b64 exec, exec, vcc
    ds_write_b32 v96, v20
    s_mov_b64 exec, vcc
    v_mbcnt_lo_u32_b32 v97, vcc_lo, 0
    v_mbcnt_hi_u32_b32 v97, vcc_hi, v97
    v_add_u32 v123, s4, v123
    v_lshl_add_u32 v97, v97, 3, s35
    ds_write2_b32 v97, v20, v123 offset0:0 offset1:1
    s_bcnt1_i32_b64 s41, vcc
    s_lshl3_add_u32 s35, s41, s35
    s_mov_b64 exec, -1
    s_cmp_ge_u32 s35, s37
    s_cbranch_scc0 acc_fs31
    s_call_b64 s[46:47], acc_gen
    v_lshrrev_b32 v120, 3, v7
    v_bitop3_b32 v122, v120, v112, v111 bitop3:0xea
    v_and_b32 v94, -9, v122
    ds_read_b128 v[54:57], v94 offset:42240
    s_waitcnt lgkmcnt(0)
    s_branch acc_fs31
acc_fs32o:
    s_andn2_b64 exec, exec, vcc
    ds_write_b32 v96, v22
    s_mov_b64 exec, vcc
    v_mbcnt_lo_u32_b32 v97, vcc_lo, 0
    v_mbcnt_hi_u32_b32 v97, vcc_hi, v97
    v_add_u32 v124, s4, v124
    v_lshl_add_u32 v97, v97, 3, s35
    ds_write2_b32 v97, v22, v124 offset0:0 offset1:1
    s_bcnt1_i32_b64 s41, vcc
    s_lshl3_add_u32 s35, s41, s35
    s_mov_b64 exec, -1
    s_cmp_ge_u32 s35, s37
    s_cbranch_scc0 acc_fs32
    s_call_b64 s[46:47], acc_gen
    v_lshrrev_b32 v120, 3, v7
    v_bitop3_b32 v122, v120, v112, v111 bitop3:0xea
    v_and_b32 v94, -9, v122
    ds_read_b128 v[54:57], v94 offset:42240
    s_waitcnt lgkmcnt(0)
    s_branch acc_fs32
acc_fs33o:
    s_andn2_b64 exec, exec, vcc
    ds_write_b32 v96, v23
    s_mov_b64 exec, vcc
    v_mbcnt_lo_u32_b32 v97, vcc_lo, 0
    v_mbcnt_hi_u32_b32 v97, vcc_hi, v97
    v_add_u32 v123, s4, v123
    v_lshl_add_u32 v97, v97, 3, s35
    ds_write2_b32 v97, v23, v123 offset0:0 offset1:1
    s_bcnt1_i32_b64 s41, vcc
    s_lshl3_add_u32 s35, s41, s35
    s_mov_b64 exec, -1
    s_cmp_ge_u32 s35, s37
    s_cbranch_scc0 acc_fs33
    s_call_b64 s[46:47], acc_gen
    v_lshrrev_b32 v119, 3, v8
    v_bitop3_b32 v121, v119, v112, v111 bitop3:0xea
    v_and_b32 v94, -9, v121
    ds_read_b128 v[54:57], v94 offset:42240
    s_waitcnt lgkmcnt(0)
    s_branch acc_fs33
acc_fs34o:
    s_andn2_b64 exec, exec, vcc
    ds_write_b32 v96, v24
    s_mov_b64 exec, vcc
    v_mbcnt_lo_u32_b32 v97, vcc_lo, 0
    v_mbcnt_hi_u32_b32 v97, vcc_hi, v97
    v_add_u32 v124, s4, v124
    v_lshl_add_u32 v97, v97, 3, s35
    ds_write2_b32 v97, v24, v124 offset0:0 offset1:1
    s_bcnt1_i32_b64 s41, vcc
    s_lshl3_add_u32 s35, s41, s35
    s_mov_b64 exec, -1
    s_cmp_ge_u32 s35, s37
    s_cbranch_scc0 acc_fs34
    s_call_b64 s[46:47], acc_gen
    v_lshrrev_b32 v119, 3, v8
    v_bitop3_b32 v121, v119, v112, v111 bitop3:0xea
    v_and_b32 v94, -9, v121
    ds_read_b128 v[54:57], v94 offset:42240
    s_waitcnt lgkmcnt(0)
    s_branch acc_fs34
acc_fs35o:
    s_andn2_b64 exec, exec, vcc
    ds_write_b32 v96, v26
    s_mov_b64 exec, vcc
    v_mbcnt_lo_u32_b32 v97, vcc_lo, 0
    v_mbcnt_hi_u32_b32 v97, vcc_hi, v97
    v_add_u32 v123, s4, v123
    v_lshl_add_u32 v97, v97, 3, s35
    ds_write2_b32 v97, v26, v123 offset0:0 offset1:1
    s_bcnt1_i32_b64 s41, vcc
    s_lshl3_add_u32 s35, s41, s35
    s_mov_b64 exec, -1
    s_cmp_ge_u32 s35, s37
    s_cbranch_scc0 acc_fs35
    s_call_b64 s[46:47], acc_gen
    v_lshrrev_b32 v120, 3, v9
    v_bitop3_b32 v122, v120, v112, v111 bitop3:0xea
    v_and_b32 v94, -9, v122
    ds_read_b128 v[54:57], v94 offset:42240
    s_waitcnt lgkmcnt(0)
    s_branch acc_fs35
acc_fs36o:
    s_andn2_b64 exec, exec, vcc
    ds_write_b32 v96, v27
    s_mov_b64 exec, vcc
    v_mbcnt_lo_u32_b32 v97, vcc_lo, 0
    v_mbcnt_hi_u32_b32 v97, vcc_hi, v97
    v_add_u32 v124, s4, v124
    v_lshl_add_u32 v97, v97, 3, s35
    ds_write2_b32 v97, v27, v124 offset0:0 offset1:1
    s_bcnt1_i32_b64 s41, vcc
    s_lshl3_add_u32 s35, s41, s35
    s_mov_b64 exec, -1
    s_cmp_ge_u32 s35, s37
    s_cbranch_scc0 acc_fs36
    s_call_b64 s[46:47], acc_gen
    v_lshrrev_b32 v120, 3, v9
    v_bitop3_b32 v122, v120, v112, v111 bitop3:0xea
    v_and_b32 v94, -9, v122
    ds_read_b128 v[54:57], v94 offset:42240
    s_waitcnt lgkmcnt(0)
    s_branch acc_fs36
acc_fs37o:
    s_andn2_b64 exec, exec, vcc
    ds_write_b32 v96, v28
    s_mov_b64 exec, vcc
    v_mbcnt_lo_u32_b32 v97, vcc_lo, 0
    v_mbcnt_hi_u32_b32 v97, vcc_hi, v97
    v_add_u32 v123, s4, v123
    v_lshl_add_u32 v97, v97, 3, s35
    ds_write2_b32 v97, v28, v123 offset0:0 offset1:1
    s_bcnt1_i32_b64 s41, vcc
    s_lshl3_add_u32 s35, s41, s35
    s_mov_b64 exec, -1
    s_cmp_ge_u32 s35, s37
    s_cbranch_scc0 acc_fs37
    s_call_b64 s[46:47], acc_gen
    v_lshrrev_b32 v119, 3, v10
    v_bitop3_b32 v121, v119, v112, v111 bitop3:0xea
    v_and_b32 v94, -9, v121
    ds_read_b128 v[54:57], v94 offset:42240
    s_waitcnt lgkmcnt(0)
    s_branch acc_fs37
acc_fs38o:
    s_andn2_b64 exec, exec, vcc
    ds_write_b32 v96, v30
    s_mov_b64 exec, vcc
    v_mbcnt_lo_u32_b32 v97, vcc_lo, 0
    v_mbcnt_hi_u32_b32 v97, vcc_hi, v97
    v_add_u32 v124, s4, v124
    v_lshl_add_u32 v97, v97, 3, s35
    ds_write2_b32 v97, v30, v124 offset0:0 offset1:1
    s_bcnt1_i32_b64 s41, vcc
    s_lshl3_add_u32 s35, s41, s35
    s_mov_b64 exec, -1
    s_cmp_ge_u32 s35, s37
    s_cbranch_scc0 acc_fs38
    s_call_b64 s[46:47], acc_gen
    v_lshrrev_b32 v119, 3, v10
    v_bitop3_b32 v121, v119, v112, v111 bitop3:0xea
    v_and_b32 v94, -9, v121
    ds_read_b128 v[54:57], v94 offset:42240
    s_waitcnt lgkmcnt(0)
    s_branch acc_fs38
acc_fs39o:
    s_andn2_b64 exec, exec, vcc
    ds_write_b32 v96, v31
    s_mov_b64 exec, vcc
    v_mbcnt_lo_u32_b32 v97, vcc_lo, 0
    v_mbcnt_hi_u32_b32 v97, vcc_hi, v97
    v_add_u32 v123, s4, v123
    v_lshl_add_u32 v97, v97, 3, s35
    ds_write2_b32 v97, v31, v123 offset0:0 offset1:1
    s_bcnt1_i32_b64 s41, vcc
    s_lshl3_add_u32 s35, s41, s35
    s_mov_b64 exec, -1
    s_cmp_ge_u32 s35, s37
    s_cbranch_scc0 acc_fs39
    s_call_b64 s[46:47], acc_gen
    v_lshrrev_b32 v120, 3, v11
    v_bitop3_b32 v122, v120, v112, v111 bitop3:0xea
    v_and_b32 v94, -9, v122
    ds_read_b128 v[54:57], v94 offset:42240
    s_waitcnt lgkmcnt(0)
    s_branch acc_fs39
acc_fs40o:
    s_andn2_b64 exec, exec, vcc
    ds_write_b32 v96, v32
    s_mov_b64 exec, vcc
    v_mbcnt_lo_u32_b32 v97, vcc_lo, 0
    v_mbcnt_hi_u32_b32 v97, vcc_hi, v97
    v_add_u32 v124, s4, v124
    v_lshl_add_u32 v97, v97, 3, s35
    ds_write2_b32 v97, v32, v124 offset0:0 offset1:1
    s_bcnt1_i32_b64 s41, vcc
    s_lshl3_add_u32 s35, s41, s35
    s_mov_b64 exec, -1
    s_cmp_ge_u32 s35, s37
    s_cbranch_scc0 acc_fs40
    s_call_b64 s[46:47], acc_gen
    v_lshrrev_b32 v120, 3, v11
    v_bitop3_b32 v122, v120, v112, v111 bitop3:0xea
    v_and_b32 v94, -9, v122
    ds_read_b128 v[54:57], v94 offset:42240
    s_waitcnt lgkmcnt(0)
    s_branch acc_fs40
acc_ck41a:
    s_setprio 0
acc_ck41c:
    ds_read_b32 v118, v111 offset:128
    s_waitcnt lgkmcnt(0)
    v_readfirstlane_b32 s41, v118
    s_cmp_ge_u32 s41, s40
    s_cbranch_scc0 acc_ck41c
    s_setprio 0
    s_branch acc_ck41b
acc_fs42o:
    s_andn2_b64 exec, exec, vcc
    ds_write_b32 v96, v34
    s_mov_b64 exec, vcc
    v_mbcnt_lo_u32_b32 v97, vcc_lo, 0
    v_mbcnt_hi_u32_b32 v97, vcc_hi, v97
    v_add_u32 v123, s4, v123
    v_lshl_add_u32 v97, v97, 3, s35
    ds_write2_b32 v97, v34, v123 offset0:0 offset1:1
    s_bcnt1_i32_b64 s41, vcc
    s_lshl3_add_u32 s35, s41, s35
    s_mov_b64 exec, -1
    s_cmp_ge_u32 s35, s37
    s_cbranch_scc0 acc_fs42
    s_call_b64 s[46:47], acc_gen0
    s_branch acc_fs42
acc_fs43o:
    s_andn2_b64 exec, exec, vcc
    ds_write_b32 v96, v35
    s_mov_b64 exec, vcc
    v_mbcnt_lo_u32_b32 v97, vcc_lo, 0
    v_mbcnt_hi_u32_b32 v97, vcc_hi, v97
    v_add_u32 v123, s4, v123
    v_lshl_add_u32 v97, v97, 3, s35
    ds_write2_b32 v97, v35, v123 offset0:0 offset1:1
    s_bcnt1_i32_b64 s41, vcc
    s_lshl3_add_u32 s35, s41, s35
    s_mov_b64 exec, -1
    s_cmp_ge_u32 s35, s37
    s_cbranch_scc0 acc_fs43
    s_call_b64 s[46:47], acc_gen0
    s_branch acc_fs43
acc_fs44o:
    s_andn2_b64 exec, exec, vcc
    ds_write_b32 v96, v36
    s_mov_b64 exec, vcc
    v_mbcnt_lo_u32_b32 v97, vcc_lo, 0
    v_mbcnt_hi_u32_b32 v97, vcc_hi, v97
    v_add_u32 v123, s4, v123
    v_lshl_add_u32 v97, v97, 3, s35
    ds_write2_b32 v97, v36, v123 offset0:0 offset1:1
    s_bcnt1_i32_b64 s41, vcc
    s_lshl3_add_u32 s35, s41, s35
    s_mov_b64 exec, -1
    s_cmp_ge_u32 s35, s37
    s_cbranch_scc0 acc_fs44
    s_call_b64 s[46:47], acc_gen0
    s_branch acc_fs44
acc_ck45a:
    s_setprio 0
acc_ck45c:
    ds_read_b32 v118, v111 offset:0
    s_waitcnt lgkmcnt(0)
    v_readfirstlane_b32 s41, v118
    s_cmp_ge_u32 s41, 64
    s_cbranch_scc0 acc_ck45c
    s_setprio 0
    s_branch acc_ck45b
code_end:
.section .rodata,"a"
.p2align 6
.amdhsa_kernel part_kernel
  .amdhsa_next_free_vgpr 128
  .amdhsa_next_free_sgpr 102
  .amdhsa_accum_offset 128
  .amdhsa_group_segment_fixed_size 0
  .amdhsa_kernarg_size 112
  .amdhsa_user_sgpr_count 2
  .amdhsa_user_sgpr_kernarg_segment_ptr 1
  .amdhsa_system_sgpr_workgroup_id_x 1
  .amdhsa_float_denorm_mode_32 3
.end_amdhsa_kernel
.p2align 6
.amdhsa_kernel accum_kernel
  .amdhsa_next_free_vgpr 128
  .amdhsa_next_free_sgpr 102
  .amdhsa_accum_offset 128
  .amdhsa_group_segment_fixed_size 0
  .amdhsa_kernarg_size 112
  .amdhsa_user_sgpr_count 2
  .amdhsa_user_sgpr_kernarg_segment_ptr 1
  .amdhsa_system_sgpr_workgroup_id_x 1
  .amdhsa_float_denorm_mode_32 3
.end_amdhsa_kernel
```
